```python
import torch

def _softmax(x, axis=-1):
    return torch.softmax(x, dim=axis)
def _gelu(x):
    return torch.nn.functional.gelu(x, approximate="tanh")
def _silu(x):
    return torch.nn.functional.silu(x)
def _sigmoid(x):
    return torch.sigmoid(x)
def _layernorm(x, axis=-1, eps=1e-5):
    m = x.mean(dim=axis, keepdim=True)
    v = x.var(dim=axis, keepdim=True, unbiased=False)
    return (x - m) / torch.sqrt(v + eps)
def _scatter_add(tgt, idx, src, axis=0):
    return tgt.clone().index_add_(axis, idx, src)
def _segment_sum(src, seg, n):
    out = torch.zeros((n,) + src.shape[1:], dtype=src.dtype)
    return out.index_add_(0, seg, src)
def _pad(x, pw):
    flat = tuple(v for pair in reversed(pw) for v in pair)
    return torch.nn.functional.pad(x, flat)

kernel_name = 'sequential_preLN__gqa_block_cached__mixer_token_mlp__decode'

def setup_inputs():

    _w = (lambda a: (lambda t: t.to(torch.bfloat16) if t.is_floating_point() else t)(torch.as_tensor(a)))
    def _A_setup():
        B, Sq, D = 2, 1, 1024
        Hq, Hkv, Sk, Dh = 32, 4, 32768, 128
        assert Hq % Hkv == 0, (Hq, Hkv)
        return {
            "x": _w((lambda *s: torch.randn(*s, dtype=torch.bfloat16) * 0.05)(B, Sq, D)),
            "k_cache": _w((lambda *s: torch.randn(*s, dtype=torch.bfloat16) * 3.2)(B, Hkv, Sk, Dh)),
            "v_cache": _w((lambda *s: torch.randn(*s, dtype=torch.bfloat16) * 0.8)(B, Hkv, Sk, Dh)),
            "wq": _w((lambda *s: torch.randn(*s, dtype=torch.bfloat16) * 3.2)(D, Hq * Dh) * (D ** -0.5)),
            "wo": _w((lambda *s: torch.randn(*s, dtype=torch.bfloat16) * 0.8)(Hq * Dh, D) * ((Hq * Dh) ** -0.5)),
        }
    _A_in = _A_setup()

    def _B_setup():
        B, S, D, F = 2, 1, 1024, 3584
        return {
            "x": _w((lambda *s: torch.randn(*s, dtype=torch.bfloat16) * 0.05)(B, S, D)),
            "w1": _w((lambda *s: torch.randn(*s, dtype=torch.bfloat16) * 1.6)(S, F) * (S ** -0.5)),
            "b1": _w((lambda *s: torch.randn(*s, dtype=torch.bfloat16) * 1.6)(F) * 0.02),
            "w2": _w((lambda *s: torch.randn(*s, dtype=torch.bfloat16) * 1.6)(F, S) * (F ** -0.5)),
            "b2": _w((lambda *s: torch.randn(*s, dtype=torch.bfloat16) * 0.8)(S) * 0.02),
        }
    _B_in = _B_setup()

    return {
        "A_x": _A_in["x"],
        "A_k_cache": _A_in["k_cache"],
        "A_v_cache": _A_in["v_cache"],
        "A_wq": _A_in["wq"],
        "A_wo": _A_in["wo"],
        "B_x": _B_in["x"],
        "B_w1": _B_in["w1"],
        "B_b1": _B_in["b1"],
        "B_w2": _B_in["w2"],
        "B_b2": _B_in["b2"],
    }

def reference(A_x, A_k_cache, A_v_cache, A_wq, A_wo, B_x, B_w1, B_b1, B_w2, B_b2):
    def _A_ref(x, k_cache, v_cache, wq, wo):
        B, Sq, D = x.shape
        Hq, Dh = 32, 128
        Hkv = k_cache.shape[1]
        rep = Hq // Hkv
        q = (lambda x, *d: x.permute(*d))((x @ wq).reshape(B, Sq, Hq, Dh), 0, 2, 1, 3)
        k = (lambda x, n, axis: torch.repeat_interleave(x, n, dim=axis))(k_cache, rep, axis=1)
        v = (lambda x, n, axis: torch.repeat_interleave(x, n, dim=axis))(v_cache, rep, axis=1)
        scores = torch.einsum("bhqd,bhkd->bhqk", q, k) * (Dh ** -0.5)
        p = _softmax(scores, axis=-1)
        o = torch.einsum("bhqk,bhkd->bhqd", p, v)
        return (lambda x, *d: x.permute(*d))(o, 0, 2, 1, 3).reshape(B, Sq, Hq * Dh) @ wo

    def _B_ref(x, w1, b1, w2, b2):
        B, S, D = x.shape
        h = _layernorm(x, axis=-1)
        u = torch.einsum("bsd,sf->bdf", h, w1) + b1
        u = _gelu(u)
        y = torch.einsum("bdf,fs->bds", u, w2) + b2
        return (lambda x, *d: x.permute(*d))(y, 0, 2, 1)

    x = A_x
    h = x + _A_ref(_layernorm(x, axis=-1), A_k_cache, A_v_cache, A_wq, A_wo)
    h2 = h + _B_ref(_layernorm(h, axis=-1), B_w1, B_b1, B_w2, B_b2)
    return h2
```

```asm
; @launch grid=(256,1,1) block=(256,1,1) lds=163840
.amdgcn_target "amdgcn-amd-amdhsa--gfx950"
.text
.globl sequential_preLN__gqa_block_cached__mixer_token_mlp__decode_kernel
.p2align 8
.type sequential_preLN__gqa_block_cached__mixer_token_mlp__decode_kernel,@function
sequential_preLN__gqa_block_cached__mixer_token_mlp__decode_kernel:
  s_cmp_ge_u32 s2, 256
  s_cbranch_scc1 L_end
  s_load_dwordx16 s[64:79], s[0:1], 0
  s_load_dwordx8 s[80:87], s[0:1], 64
  s_load_dwordx2 s[88:89], s[0:1], 96
  v_lshrrev_b32 v196, 6, v0
  v_and_b32 v1, 63, v0
  v_readfirstlane_b32 s52, v196
  v_and_b32 v32, 15, v1
  v_lshrrev_b32 v33, 4, v1
  s_mov_b32 s22, 4096
  s_mov_b32 s23, 0x20000
  s_mov_b32 s14, 8388608
  s_mov_b32 s15, 0x20000
  s_mov_b32 s6, 67108864
  s_mov_b32 s7, 0x20000
  s_mov_b32 s26, 268435456
  s_mov_b32 s27, 0x20000
  s_mov_b32 s10, 67108864
  s_mov_b32 s11, 0x20000
  s_mov_b32 s18, 8388608
  s_mov_b32 s19, 0x20000
  s_mov_b32 s30, 256
  s_mov_b32 s31, 0x20000
  s_mov_b32 s34, 4096
  s_mov_b32 s35, 0x20000
  s_mov_b32 s38, 7168
  s_mov_b32 s39, 0x20000
  s_mov_b32 s42, 7168
  s_mov_b32 s43, 0x20000
  s_mov_b32 s46, 7168
  s_mov_b32 s47, 0x20000
  s_mov_b32 s50, 2
  s_mov_b32 s51, 0x20000
  s_and_b32 s53, s2, 7
  s_lshr_b32 s54, s2, 3
  s_lshl_b32 s59, s54, 2
  s_add_u32 s59, s59, s52
  s_lshl_b32 s59, s59, 12
  s_lshl_b32 s55, s53, 23
  s_add_u32 s55, s55, s59
  s_lshl_b32 s56, s52, 15
  s_lshr_b32 s59, s2, 6
  s_lshl_b32 s59, s59, 2
  s_add_u32 s59, s59, s52
  s_lshl_b32 s60, s59, 6
  s_lshl_b32 s57, s60, 13
  s_and_b32 s61, s2, 3
  s_lshl_b32 s61, s61, 11
  s_add_u32 s57, s57, s61
  s_bfe_u32 s61, s2, 0x40002
  s_lshl_b32 s61, s61, 7
  s_add_u32 s57, s57, s61
  v_lshlrev_b32 v202, 5, v1
  v_and_b32 v196, 1, v32
  v_lshlrev_b32 v196, 11, v196
  v_lshl_add_u32 v196, v33, 3, v196
  s_lshl_b32 s60, s60, 1
  v_add_u32 v203, s60, v196
  v_lshrrev_b32 v196, 3, v1
  v_bfe_u32 v197, v1, 1, 2
  v_bfe_u32 v198, v1, 4, 2
  v_xor_b32 v197, v197, v198
  v_lshlrev_b32 v197, 5, v197
  v_and_b32 v198, 1, v1
  v_lshl_or_b32 v197, v198, 4, v197
  v_lshl_or_b32 v8, v196, 13, v197
  v_lshl_or_b32 v9, v196, 11, v197
  v_xor_b32 v196, v32, v33
  v_lshlrev_b32 v197, 8, v33
  v_lshlrev_b32 v198, 8, v32
  v_add_u32 v198, s56, v198
  v_xor_b32 v199, 0, v196
  v_lshl_or_b32 v2, v199, 4, v197
  v_lshl_add_u32 v10, v199, 4, v198
  v_xor_b32 v199, 4, v196
  v_lshl_or_b32 v3, v199, 4, v197
  v_lshl_add_u32 v11, v199, 4, v198
  v_xor_b32 v199, 8, v196
  v_lshl_or_b32 v4, v199, 4, v197
  v_lshl_add_u32 v12, v199, 4, v198
  v_xor_b32 v199, 12, v196
  v_lshl_or_b32 v5, v199, 4, v197
  v_lshl_add_u32 v13, v199, 4, v198
  s_bfe_u32 s94, s2, 0x10000
  s_lshl_b32 s94, s94, 7
  s_lshr_b32 s95, s2, 1
  s_or_b32 s94, s94, s95
  s_and_b32 s95, s94, 7
  v_mov_b32 v204, 2147483648
  s_and_b32 s59, s2, 3
  s_lshl_b32 s59, s59, 1
  s_lshr_b32 s60, s52, 1
  s_add_u32 s59, s59, s60
  s_lshl_b32 s59, s59, 2
  s_lshr_b32 s61, s2, 6
  s_add_u32 s59, s59, s61
  s_lshl_b32 s59, s59, 12
  s_bfe_u32 s61, s2, 0x40002
  s_lshl_b32 s61, s61, 8
  s_add_u32 s59, s59, s61
  s_and_b32 s61, s52, 1
  s_lshl_b32 s61, s61, 7
  s_add_u32 s59, s59, s61
  s_add_u32 s59, s59, 0
  v_lshlrev_b32 v196, 4, v1
  v_cmp_gt_u32 vcc, 8, v1
  v_add_u32 v197, s59, v196
  s_nop 0
  v_cndmask_b32 v26, v204, v197, vcc
  s_lshl_b32 s59, s60, 3
  s_and_b32 s62, s95, 3
  s_lshl_b32 s62, s62, 1
  s_lshr_b32 s60, s95, 2
  s_add_u32 s62, s62, s60
  s_add_u32 s59, s59, s62
  s_lshl_b32 s59, s59, 12
  s_add_u32 s59, s59, s61
  s_bfe_u32 s61, s94, 0x40003
  s_lshl_b32 s61, s61, 8
  s_add_u32 s59, s59, s61
  s_add_u32 s59, s59, 2228224
  s_cmp_lt_u32 s94, 128
  s_cselect_b32 s59, s59, 2147483648
  v_add_u32 v197, s59, v196
  v_cndmask_b32 v30, v204, v197, vcc
  s_lshl_b32 s59, s53, 17
  s_lshl_b32 s60, s54, 6
  s_add_u32 s59, s59, s60
  s_add_u32 s59, s59, 1048576
  v_lshrrev_b32 v197, 2, v0
  v_lshlrev_b32 v197, 11, v197
  v_and_b32 v198, 3, v0
  v_lshl_or_b32 v197, v198, 4, v197
  v_add_u32 v27, s59, v197
  s_lshl_b32 s59, s53, 11
  s_lshl_b32 s60, s54, 3
  s_add_u32 s59, s59, s60
  s_add_u32 s59, s59, 2097152
  s_cmp_eq_u32 s52, 0
  s_cselect_b32 s59, s59, 2147483648
  v_lshlrev_b32 v197, 8, v1
  v_add_u32 v197, s59, v197
  v_cndmask_b32 v28, v204, v197, vcc
  s_lshl_b32 s59, s2, 5
  s_add_u32 s59, s59, 2293760
  s_cmp_eq_u32 s52, 0
  s_cselect_b32 s59, s59, 2147483648
  v_cmp_gt_u32 vcc, 16, v1
  v_lshrrev_b32 v197, 3, v1
  v_lshlrev_b32 v197, 13, v197
  v_and_b32 v198, 7, v1
  v_lshl_or_b32 v197, v198, 2, v197
  v_add_u32 v197, s59, v197
  v_cndmask_b32 v31, v204, v197, vcc
  s_lshr_b32 s59, s95, 2
  s_lshl_b32 s59, s59, 13
  s_and_b32 s60, s95, 3
  s_lshl_b32 s60, s60, 11
  s_add_u32 s59, s59, s60
  s_bfe_u32 s60, s94, 0x40003
  s_lshl_b32 s60, s60, 7
  s_add_u32 s59, s59, s60
  s_lshl_b32 s60, s52, 5
  s_add_u32 s59, s59, s60
  s_add_u32 s59, s59, 2162688
  s_cmp_ge_u32 s94, 128
  s_cselect_b32 s59, s59, 2147483648
  v_and_b32 v197, 1, v1
  v_lshlrev_b32 v197, 4, v197
  v_lshrrev_b32 v198, 5, v1
  v_lshl_or_b32 v197, v198, 3, v197
  v_bfe_u32 v198, v1, 4, 1
  v_lshl_or_b32 v197, v198, 2, v197
  v_add_u32 v197, s59, v197
  v_and_b32 v198, 14, v1
  v_cmp_eq_u32 vcc, 0, v198
  s_nop 1
  v_cndmask_b32 v29, v204, v197, vcc
  s_and_b32 s59, s2, 3
  s_lshl_b32 s59, s59, 6
  s_lshr_b32 s60, s2, 2
  s_add_u32 s59, s59, s60
  s_cmp_eq_u32 s52, 0
  s_cselect_b32 s59, s59, 0x1000
  v_mov_b32 v246, 0x1000
  v_mov_b32 v247, s59
  v_cmp_eq_u32 vcc, 0, v1
  s_nop 1
  v_cndmask_b32 v246, v246, v247, vcc
  v_mov_b32 v247, 1
  s_waitcnt lgkmcnt(0)
  s_mov_b32 s20, s64
  s_mov_b32 s21, s65
  s_mov_b32 s12, s70
  s_mov_b32 s13, s71
  s_mov_b32 s24, s88
  s_mov_b32 s25, s89
  s_mov_b32 s4, s66
  s_mov_b32 s5, s67
  s_mov_b32 s36, s76
  s_mov_b32 s37, s77
  s_mov_b32 s40, s78
  s_mov_b32 s41, s79
  s_mov_b32 s44, s80
  s_mov_b32 s45, s81
  s_mov_b32 s48, s82
  s_mov_b32 s49, s83
  s_mov_b32 s8, s68
  s_mov_b32 s9, s69
  s_mov_b32 s16, s72
  s_mov_b32 s17, s73
  s_mov_b32 s32, s84
  s_mov_b32 s33, s85
  s_mov_b32 s28, s86
  s_mov_b32 s29, s87
  s_lshl_b32 s59, s52, 10
  v_lshl_add_u32 v205, v1, 4, s59
  s_add_u32 m0, s59, 141312
  s_nop 0
  buffer_load_dwordx4 v205, s[20:23], 0 offen lds
  v_mov_b32 v208, -1
  v_mov_b32 v209, -1
  v_mov_b32 v210, -1
  v_mov_b32 v211, -1
  buffer_store_dwordx4 v[208:211], v26, s[24:27], 0 offen sc1
  buffer_store_dwordx4 v[208:211], v27, s[24:27], 0 offen sc1
  buffer_store_dwordx4 v[208:211], v30, s[24:27], 0 offen sc1
  buffer_store_dwordx2 v[208:209], v28, s[24:27], 0 offen sc1
  buffer_store_dword v208, v29, s[24:27], 0 offen sc1
  buffer_store_dword v208, v31, s[24:27], 0 offen sc1
  s_add_u32 m0, s56, 0
  s_add_u32 s3, s55, 0
  buffer_load_dwordx4 v2, s[4:7], s3 offen offset:0 nt lds
  buffer_load_dwordx4 v3, s[4:7], s3 offen offset:1024 nt lds
  buffer_load_dwordx4 v4, s[4:7], s3 offen offset:2048 nt lds
  buffer_load_dwordx4 v5, s[4:7], s3 offen offset:3072 nt lds
  s_add_u32 m0, s56, 4096
  s_add_u32 s3, s55, 524288
  buffer_load_dwordx4 v2, s[4:7], s3 offen offset:0 nt lds
  buffer_load_dwordx4 v3, s[4:7], s3 offen offset:1024 nt lds
  buffer_load_dwordx4 v4, s[4:7], s3 offen offset:2048 nt lds
  buffer_load_dwordx4 v5, s[4:7], s3 offen offset:3072 nt lds
  v_lshrrev_b32 v196, 1, v32
  v_and_b32 v198, 1, v32
  v_lshlrev_b32 v198, 4, v198
  v_lshl_or_b32 v198, v33, 8, v198
  v_xor_b32 v197, v196, v33
  v_lshl_add_u32 v6, v197, 5, v198
  v_xor_b32 v197, v196, v33
  v_xor_b32 v197, 4, v197
  v_lshl_add_u32 v7, v197, 5, v198
  v_lshrrev_b32 v196, 2, v32
  v_lshl_add_u32 v196, v33, 2, v196
  v_and_b32 v197, 3, v32
  v_lshlrev_b32 v197, 3, v197
  v_add_u32 v197, s56, v197
  v_lshl_add_u32 v198, v196, 8, v197
  v_and_b32 v199, 7, v196
  v_xor_b32 v200, 0, v199
  v_lshl_add_u32 v14, v200, 5, v198
  v_xor_b32 v200, 1, v199
  v_lshl_add_u32 v15, v200, 5, v198
  v_xor_b32 v200, 2, v199
  v_lshl_add_u32 v16, v200, 5, v198
  v_xor_b32 v200, 3, v199
  v_lshl_add_u32 v17, v200, 5, v198
  v_xor_b32 v200, 4, v199
  v_lshl_add_u32 v18, v200, 5, v198
  v_xor_b32 v200, 5, v199
  v_lshl_add_u32 v19, v200, 5, v198
  v_xor_b32 v200, 6, v199
  v_lshl_add_u32 v20, v200, 5, v198
  v_xor_b32 v200, 7, v199
  v_lshl_add_u32 v21, v200, 5, v198
  v_lshl_add_u32 v198, v196, 7, v197
  v_bfe_u32 v199, v196, 1, 2
  v_xor_b32 v200, 0, v199
  v_lshl_add_u32 v22, v200, 5, v198
  v_xor_b32 v200, 1, v199
  v_lshl_add_u32 v23, v200, 5, v198
  v_xor_b32 v200, 2, v199
  v_lshl_add_u32 v24, v200, 5, v198
  v_xor_b32 v200, 3, v199
  v_lshl_add_u32 v25, v200, 5, v198
  s_and_b32 s59, s95, 3
  s_lshl_b32 s59, s59, 1
  s_lshr_b32 s60, s95, 2
  s_add_u32 s59, s59, s60
  s_lshl_b32 s59, s59, 2
  s_add_u32 s59, s59, s52
  s_lshl_b32 s58, s59, 18
  s_bfe_u32 s61, s94, 0x40003
  s_lshl_b32 s61, s61, 7
  s_add_u32 s58, s58, s61
  s_cmp_lt_u32 s94, 128
  s_cselect_b32 s59, 0, 2147483648
  v_or_b32 v9, s59, v9
  s_and_b32 s59, s94, 0xfe
  s_cmp_eq_u32 s59, 128
  s_mov_b32 s60, 2147483648
  s_cselect_b32 s59, 2293760, s60
  v_lshl_add_u32 v80, v0, 4, s59
  v_mov_b32 v36, 0xc0135761
  v_mov_b32 v37, 0xc0135761
  v_mov_b32 v38, 1.0
  v_mov_b32 v39, 1.0
  s_mov_b32 s100, 0xbdd2d3e8
  s_mov_b32 s101, 0xbdd2d3e8
  s_lshl_b32 s97, s2, 3
  s_add_u32 s97, s97, 14592
  s_lshl_b32 s97, s97, 16
  v_mov_b32 v84, 0
  v_mov_b32 v85, 0
  v_mov_b32 v86, 0
  v_mov_b32 v87, 0
  v_mov_b32 v88, 0
  v_mov_b32 v89, 0
  v_mov_b32 v90, 0
  v_mov_b32 v91, 0
  v_mov_b32 v92, 0
  v_mov_b32 v93, 0
  v_mov_b32 v94, 0
  v_mov_b32 v95, 0
  v_mov_b32 v96, 0
  v_mov_b32 v97, 0
  v_mov_b32 v98, 0
  v_mov_b32 v99, 0
  v_and_b32 v196, 7, v32
  v_mul_u32_u24 v196, 576, v196
  v_lshl_add_u32 v196, v33, 4, v196
  s_mul_i32 s59, s52, 4608
  s_add_u32 s59, s59, 145408
  v_add_u32 v34, s59, v196
  v_lshrrev_b32 v196, 5, v0
  v_mul_u32_u24 v196, 576, v196
  v_and_b32 v197, 31, v0
  v_lshl_add_u32 v196, v197, 4, v196
  v_add_u32 v35, 145408, v196
  s_and_b32 s59, s53, 3
  s_lshl_b32 s59, s59, 1
  s_lshr_b32 s60, s53, 2
  s_add_u32 s59, s59, s60
  s_lshl_b32 s59, s59, 14
  s_add_u32 s59, s59, 0
  v_lshl_add_u32 v78, v0, 4, s59
  v_and_b32 v196, 7, v32
  v_lshlrev_b32 v196, 8, v196
  v_lshl_add_u32 v196, v33, 4, v196
  v_add_u32 v79, 133120, v196
  s_waitcnt vmcnt(14)
  s_barrier
  buffer_store_byte v247, v246, s[28:31], 0 offen sc1
  v_lshlrev_b32 v202, 4, v1
  v_add_u32 v202, 141312, v202
  v_add_u32 v203, 141312, v203
  ds_read_b128 v[100:103], v202 offset:0
  ds_read_b128 v[104:107], v202 offset:1024
  ds_read_b128 v[108:111], v202 offset:2048
  ds_read_b128 v[112:115], v202 offset:3072
  ds_read_b64 v[116:117], v203 offset:0
  ds_read_b64 v[118:119], v203 offset:32
  ds_read_b64 v[120:121], v203 offset:64
  ds_read_b64 v[122:123], v203 offset:96
  s_waitcnt vmcnt(5) lgkmcnt(0)
  ds_read_b128 a[0:3], v10 offset:0
  ds_read_b128 a[4:7], v11 offset:0
  ds_read_b128 a[8:11], v12 offset:0
  ds_read_b128 a[12:15], v13 offset:0
  s_add_u32 m0, s56, 8192
  s_add_u32 s3, s57, 0
  buffer_load_dwordx4 v8, s[12:15], s3 offen offset:0 nt lds
  v_lshlrev_b32 v148, 16, v100
  v_and_b32 v149, 0xffff0000, v100
  v_lshlrev_b32 v150, 16, v101
  v_and_b32 v151, 0xffff0000, v101
  s_add_u32 s3, s57, 64512
  buffer_load_dwordx4 v8, s[12:15], s3 offen offset:1024 nt lds
  v_lshlrev_b32 v152, 16, v102
  v_and_b32 v153, 0xffff0000, v102
  v_lshlrev_b32 v154, 16, v103
  v_and_b32 v155, 0xffff0000, v103
  v_lshlrev_b32 v156, 16, v104
  s_add_u32 s3, s57, 129024
  buffer_load_dwordx4 v8, s[12:15], s3 offen offset:2048 nt lds
  v_and_b32 v157, 0xffff0000, v104
  v_lshlrev_b32 v158, 16, v105
  v_and_b32 v159, 0xffff0000, v105
  v_lshlrev_b32 v160, 16, v106
  v_and_b32 v161, 0xffff0000, v106
  s_add_u32 s3, s57, 193536
  buffer_load_dwordx4 v8, s[12:15], s3 offen offset:3072 nt lds
  v_lshlrev_b32 v162, 16, v107
  v_and_b32 v163, 0xffff0000, v107
  v_lshlrev_b32 v212, 16, v108
  v_and_b32 v213, 0xffff0000, v108
  v_lshlrev_b32 v214, 16, v109
  s_add_u32 m0, s56, 12288
  s_add_u32 s3, s57, 262144
  buffer_load_dwordx4 v8, s[12:15], s3 offen offset:0 nt lds
  v_and_b32 v215, 0xffff0000, v109
  v_lshlrev_b32 v216, 16, v110
  v_and_b32 v217, 0xffff0000, v110
  v_lshlrev_b32 v218, 16, v111
  v_and_b32 v219, 0xffff0000, v111
  s_add_u32 s3, s57, 326656
  buffer_load_dwordx4 v8, s[12:15], s3 offen offset:1024 nt lds
  v_lshlrev_b32 v220, 16, v112
  v_and_b32 v221, 0xffff0000, v112
  v_lshlrev_b32 v222, 16, v113
  v_and_b32 v223, 0xffff0000, v113
  s_add_u32 s3, s57, 391168
  buffer_load_dwordx4 v8, s[12:15], s3 offen offset:2048 nt lds
  v_lshlrev_b32 v224, 16, v114
  v_and_b32 v225, 0xffff0000, v114
  v_lshlrev_b32 v226, 16, v115
  v_and_b32 v227, 0xffff0000, v115
  v_pk_add_f32 v[204:205], v[148:149], v[150:151]
  s_add_u32 s3, s57, 455680
  buffer_load_dwordx4 v8, s[12:15], s3 offen offset:3072 nt lds
  v_pk_add_f32 v[206:207], v[212:213], v[214:215]
  v_pk_add_f32 v[204:205], v[204:205], v[152:153]
  v_pk_add_f32 v[206:207], v[206:207], v[216:217]
  v_pk_add_f32 v[204:205], v[204:205], v[154:155]
  v_pk_add_f32 v[206:207], v[206:207], v[218:219]
  s_add_u32 m0, s56, 16384
  s_add_u32 s3, s55, 1048576
  buffer_load_dwordx4 v2, s[4:7], s3 offen offset:0 nt lds
  v_pk_add_f32 v[204:205], v[204:205], v[156:157]
  v_pk_add_f32 v[206:207], v[206:207], v[220:221]
  v_pk_add_f32 v[204:205], v[204:205], v[158:159]
  v_pk_add_f32 v[206:207], v[206:207], v[222:223]
  v_pk_add_f32 v[204:205], v[204:205], v[160:161]
  buffer_load_dwordx4 v3, s[4:7], s3 offen offset:1024 nt lds
  v_pk_add_f32 v[206:207], v[206:207], v[224:225]
  v_pk_add_f32 v[204:205], v[204:205], v[162:163]
  v_pk_add_f32 v[206:207], v[206:207], v[226:227]
  v_add_f32 v196, v204, v205
  v_add_f32 v198, v206, v207
  buffer_load_dwordx4 v4, s[4:7], s3 offen offset:2048 nt lds
  v_add_f32_dpp v196, v196, v196 row_ror:8 row_mask:0xf bank_mask:0xf
  v_add_f32_dpp v198, v198, v198 row_ror:8 row_mask:0xf bank_mask:0xf
  s_nop 0
  v_add_f32_dpp v196, v196, v196 row_ror:4 row_mask:0xf bank_mask:0xf
  v_add_f32_dpp v198, v198, v198 row_ror:4 row_mask:0xf bank_mask:0xf
  buffer_load_dwordx4 v5, s[4:7], s3 offen offset:3072 nt lds
  v_add_f32_dpp v196, v196, v196 row_ror:2 row_mask:0xf bank_mask:0xf
  v_add_f32_dpp v198, v198, v198 row_ror:2 row_mask:0xf bank_mask:0xf
  s_nop 0
  v_add_f32_dpp v196, v196, v196 row_ror:1 row_mask:0xf bank_mask:0xf
  v_add_f32_dpp v198, v198, v198 row_ror:1 row_mask:0xf bank_mask:0xf
  v_mov_b32 v200, v196
  s_add_u32 m0, s56, 20480
  s_add_u32 s3, s55, 1572864
  buffer_load_dwordx4 v2, s[4:7], s3 offen offset:0 nt lds
  v_mov_b32 v201, v198
  v_permlane16_swap_b32 v196, v200
  s_nop 0
  v_permlane16_swap_b32 v198, v201
  v_add_f32 v196, v196, v200
  v_add_f32 v198, v198, v201
  buffer_load_dwordx4 v3, s[4:7], s3 offen offset:1024 nt lds
  v_mov_b32 v200, v196
  v_mov_b32 v201, v198
  s_nop 0
  v_permlane32_swap_b32 v196, v200
  v_permlane32_swap_b32 v198, v201
  v_add_f32 v196, v196, v200
  buffer_load_dwordx4 v4, s[4:7], s3 offen offset:2048 nt lds
  v_add_f32 v198, v198, v201
  v_mul_f32 v196, 0x3a800000, v196
  v_mul_f32 v198, 0x3a800000, v198
  v_pk_add_f32 v[148:149], v[148:149], v[196:197] op_sel_hi:[1,0] neg_lo:[0,1] neg_hi:[0,1]
  v_pk_add_f32 v[212:213], v[212:213], v[198:199] op_sel_hi:[1,0] neg_lo:[0,1] neg_hi:[0,1]
  buffer_load_dwordx4 v5, s[4:7], s3 offen offset:3072 nt lds
  v_pk_add_f32 v[150:151], v[150:151], v[196:197] op_sel_hi:[1,0] neg_lo:[0,1] neg_hi:[0,1]
  v_pk_add_f32 v[214:215], v[214:215], v[198:199] op_sel_hi:[1,0] neg_lo:[0,1] neg_hi:[0,1]
  v_pk_add_f32 v[152:153], v[152:153], v[196:197] op_sel_hi:[1,0] neg_lo:[0,1] neg_hi:[0,1]
  v_pk_add_f32 v[216:217], v[216:217], v[198:199] op_sel_hi:[1,0] neg_lo:[0,1] neg_hi:[0,1]
  v_pk_add_f32 v[154:155], v[154:155], v[196:197] op_sel_hi:[1,0] neg_lo:[0,1] neg_hi:[0,1]
  v_pk_add_f32 v[218:219], v[218:219], v[198:199] op_sel_hi:[1,0] neg_lo:[0,1] neg_hi:[0,1]
  v_pk_add_f32 v[156:157], v[156:157], v[196:197] op_sel_hi:[1,0] neg_lo:[0,1] neg_hi:[0,1]
  v_pk_add_f32 v[220:221], v[220:221], v[198:199] op_sel_hi:[1,0] neg_lo:[0,1] neg_hi:[0,1]
  v_pk_add_f32 v[158:159], v[158:159], v[196:197] op_sel_hi:[1,0] neg_lo:[0,1] neg_hi:[0,1]
  v_pk_add_f32 v[222:223], v[222:223], v[198:199] op_sel_hi:[1,0] neg_lo:[0,1] neg_hi:[0,1]
  v_pk_add_f32 v[160:161], v[160:161], v[196:197] op_sel_hi:[1,0] neg_lo:[0,1] neg_hi:[0,1]
  v_pk_add_f32 v[224:225], v[224:225], v[198:199] op_sel_hi:[1,0] neg_lo:[0,1] neg_hi:[0,1]
  v_pk_add_f32 v[162:163], v[162:163], v[196:197] op_sel_hi:[1,0] neg_lo:[0,1] neg_hi:[0,1]
  v_pk_add_f32 v[226:227], v[226:227], v[198:199] op_sel_hi:[1,0] neg_lo:[0,1] neg_hi:[0,1]
  v_pk_mul_f32 v[204:205], v[148:149], v[148:149]
  v_pk_mul_f32 v[206:207], v[212:213], v[212:213]
  v_pk_fma_f32 v[204:205], v[150:151], v[150:151], v[204:205]
  v_pk_fma_f32 v[206:207], v[214:215], v[214:215], v[206:207]
  v_pk_fma_f32 v[204:205], v[152:153], v[152:153], v[204:205]
  v_pk_fma_f32 v[206:207], v[216:217], v[216:217], v[206:207]
  v_pk_fma_f32 v[204:205], v[154:155], v[154:155], v[204:205]
  v_pk_fma_f32 v[206:207], v[218:219], v[218:219], v[206:207]
  v_pk_fma_f32 v[204:205], v[156:157], v[156:157], v[204:205]
  v_pk_fma_f32 v[206:207], v[220:221], v[220:221], v[206:207]
  v_pk_fma_f32 v[204:205], v[158:159], v[158:159], v[204:205]
  v_pk_fma_f32 v[206:207], v[222:223], v[222:223], v[206:207]
  v_pk_fma_f32 v[204:205], v[160:161], v[160:161], v[204:205]
  v_pk_fma_f32 v[206:207], v[224:225], v[224:225], v[206:207]
  v_pk_fma_f32 v[204:205], v[162:163], v[162:163], v[204:205]
  v_pk_fma_f32 v[206:207], v[226:227], v[226:227], v[206:207]
  v_add_f32 v202, v204, v205
  v_add_f32 v203, v206, v207
  s_nop 0
  v_add_f32_dpp v202, v202, v202 row_ror:8 row_mask:0xf bank_mask:0xf
  v_add_f32_dpp v203, v203, v203 row_ror:8 row_mask:0xf bank_mask:0xf
  s_nop 0
  v_add_f32_dpp v202, v202, v202 row_ror:4 row_mask:0xf bank_mask:0xf
  v_add_f32_dpp v203, v203, v203 row_ror:4 row_mask:0xf bank_mask:0xf
  s_nop 0
  v_add_f32_dpp v202, v202, v202 row_ror:2 row_mask:0xf bank_mask:0xf
  v_add_f32_dpp v203, v203, v203 row_ror:2 row_mask:0xf bank_mask:0xf
  s_waitcnt vmcnt(17) lgkmcnt(0)
  ds_read_b128 a[16:19], v10 offset:4096
  ds_read_b128 a[20:23], v11 offset:4096
  ds_read_b128 a[24:27], v12 offset:4096
  ds_read_b128 a[28:31], v13 offset:4096
  s_add_u32 m0, s56, 24576
  s_add_u32 s3, s55, 2097152
  buffer_load_dwordx4 v2, s[4:7], s3 offen offset:0 nt lds
  v_add_f32_dpp v202, v202, v202 row_ror:1 row_mask:0xf bank_mask:0xf
  v_add_f32_dpp v203, v203, v203 row_ror:1 row_mask:0xf bank_mask:0xf
  v_mov_b32 v200, v202
  v_mov_b32 v201, v203
  s_nop 0
  v_permlane16_swap_b32 v202, v200
  v_permlane16_swap_b32 v203, v201
  v_add_f32 v202, v202, v200
  v_add_f32 v203, v203, v201
  v_mov_b32 v200, v202
  v_mov_b32 v201, v203
  s_nop 0
  v_permlane32_swap_b32 v202, v200
  v_permlane32_swap_b32 v203, v201
  v_add_f32 v202, v202, v200
  v_add_f32 v203, v203, v201
  v_mul_f32 v202, 0x3a800000, v202
  buffer_load_dwordx4 v3, s[4:7], s3 offen offset:1024 nt lds
  v_mul_f32 v203, 0x3a800000, v203
  v_cvt_pk_bf16_f32 v196, 0, v196
  v_cvt_pk_bf16_f32 v198, 0, v198
  v_cvt_pk_bf16_f32 v202, 0, v202
  v_cvt_pk_bf16_f32 v203, 0, v203
  v_add_f32 v202, 0x3727c5ac, v202
  v_add_f32 v203, 0x3727c5ac, v203
  v_cvt_pk_bf16_f32 v202, 0, v202
  v_cvt_pk_bf16_f32 v203, 0, v203
  v_sqrt_f32 v202, v202
  v_sqrt_f32 v203, v203
  v_cvt_pk_bf16_f32 v202, 0, v202
  v_cvt_pk_bf16_f32 v203, 0, v203
  v_rcp_f32 v202, v202
  v_rcp_f32 v203, v203
  v_and_b32 v200, 1, v32
  buffer_load_dwordx4 v4, s[4:7], s3 offen offset:2048 nt lds
  v_cmp_eq_u32 vcc, 1, v200
  s_nop 1
  v_cndmask_b32 v204, v196, v198, vcc
  v_cndmask_b32 v206, v202, v203, vcc
  v_lshlrev_b32 v212, 16, v116
  v_and_b32 v213, 0xffff0000, v116
  v_lshlrev_b32 v214, 16, v117
  v_and_b32 v215, 0xffff0000, v117
  v_lshlrev_b32 v216, 16, v118
  v_and_b32 v217, 0xffff0000, v118
  v_lshlrev_b32 v218, 16, v119
  v_and_b32 v219, 0xffff0000, v119
  v_lshlrev_b32 v220, 16, v120
  v_and_b32 v221, 0xffff0000, v120
  v_lshlrev_b32 v222, 16, v121
  v_and_b32 v223, 0xffff0000, v121
  v_lshlrev_b32 v224, 16, v122
  buffer_load_dwordx4 v5, s[4:7], s3 offen offset:3072 nt lds
  v_and_b32 v225, 0xffff0000, v122
  v_lshlrev_b32 v226, 16, v123
  v_and_b32 v227, 0xffff0000, v123
  v_pk_add_f32 v[212:213], v[212:213], v[204:205] op_sel_hi:[1,0] neg_lo:[0,1] neg_hi:[0,1]
  v_pk_add_f32 v[214:215], v[214:215], v[204:205] op_sel_hi:[1,0] neg_lo:[0,1] neg_hi:[0,1]
  v_pk_add_f32 v[216:217], v[216:217], v[204:205] op_sel_hi:[1,0] neg_lo:[0,1] neg_hi:[0,1]
  v_pk_add_f32 v[218:219], v[218:219], v[204:205] op_sel_hi:[1,0] neg_lo:[0,1] neg_hi:[0,1]
  v_pk_add_f32 v[220:221], v[220:221], v[204:205] op_sel_hi:[1,0] neg_lo:[0,1] neg_hi:[0,1]
  v_pk_add_f32 v[222:223], v[222:223], v[204:205] op_sel_hi:[1,0] neg_lo:[0,1] neg_hi:[0,1]
  v_pk_add_f32 v[224:225], v[224:225], v[204:205] op_sel_hi:[1,0] neg_lo:[0,1] neg_hi:[0,1]
  v_pk_add_f32 v[226:227], v[226:227], v[204:205] op_sel_hi:[1,0] neg_lo:[0,1] neg_hi:[0,1]
  v_cvt_pk_bf16_f32 v212, 0, v212
  v_cvt_pk_bf16_f32 v213, 0, v213
  v_cvt_pk_bf16_f32 v214, 0, v214
  v_cvt_pk_bf16_f32 v215, 0, v215
  v_cvt_pk_bf16_f32 v216, 0, v216
  v_cvt_pk_bf16_f32 v217, 0, v217
  v_cvt_pk_bf16_f32 v218, 0, v218
  v_cvt_pk_bf16_f32 v219, 0, v219
  v_cvt_pk_bf16_f32 v220, 0, v220
  v_cvt_pk_bf16_f32 v221, 0, v221
  v_cvt_pk_bf16_f32 v222, 0, v222
  v_cvt_pk_bf16_f32 v223, 0, v223
  v_cvt_pk_bf16_f32 v224, 0, v224
  v_cvt_pk_bf16_f32 v225, 0, v225
  v_cvt_pk_bf16_f32 v226, 0, v226
  v_cvt_pk_bf16_f32 v227, 0, v227
  v_pk_mul_f32 v[212:213], v[212:213], v[206:207] op_sel_hi:[1,0]
  v_pk_mul_f32 v[214:215], v[214:215], v[206:207] op_sel_hi:[1,0]
  v_pk_mul_f32 v[216:217], v[216:217], v[206:207] op_sel_hi:[1,0]
  v_pk_mul_f32 v[218:219], v[218:219], v[206:207] op_sel_hi:[1,0]
  v_pk_mul_f32 v[220:221], v[220:221], v[206:207] op_sel_hi:[1,0]
  v_pk_mul_f32 v[222:223], v[222:223], v[206:207] op_sel_hi:[1,0]
  v_pk_mul_f32 v[224:225], v[224:225], v[206:207] op_sel_hi:[1,0]
  v_pk_mul_f32 v[226:227], v[226:227], v[206:207] op_sel_hi:[1,0]
  v_cvt_pk_bf16_f32 v116, v212, v213
  v_cvt_pk_bf16_f32 v117, v214, v215
  v_cvt_pk_bf16_f32 v118, v216, v217
  v_cvt_pk_bf16_f32 v119, v218, v219
  v_cvt_pk_bf16_f32 v120, v220, v221
  v_cvt_pk_bf16_f32 v121, v222, v223
  v_cvt_pk_bf16_f32 v122, v224, v225
  v_cvt_pk_bf16_f32 v123, v226, v227
  s_waitcnt vmcnt(8) lgkmcnt(0)
  ds_read_b128 a[32:35], v10 offset:16384
  ds_read_b128 a[36:39], v11 offset:16384
  ds_read_b128 a[40:43], v12 offset:16384
  ds_read_b128 a[44:47], v13 offset:16384
  ds_read_b64_tr_b16 v[212:213], v22 offset:8192
  ds_read_b64_tr_b16 v[214:215], v22 offset:10240
  ds_read_b64_tr_b16 v[216:217], v23 offset:8192
  ds_read_b64_tr_b16 v[218:219], v23 offset:10240
  ds_read_b64_tr_b16 v[220:221], v24 offset:8192
  ds_read_b64_tr_b16 v[222:223], v24 offset:10240
  ds_read_b64_tr_b16 v[224:225], v25 offset:8192
  ds_read_b64_tr_b16 v[226:227], v25 offset:10240
  ds_read_b64_tr_b16 v[228:229], v22 offset:12288
  ds_read_b64_tr_b16 v[230:231], v22 offset:14336
  ds_read_b64_tr_b16 v[232:233], v23 offset:12288
  ds_read_b64_tr_b16 v[234:235], v23 offset:14336
  ds_read_b64_tr_b16 v[236:237], v24 offset:12288
  ds_read_b64_tr_b16 v[238:239], v24 offset:14336
  ds_read_b64_tr_b16 v[240:241], v25 offset:12288
  ds_read_b64_tr_b16 v[242:243], v25 offset:14336
  s_add_u32 m0, s56, 28672
  s_add_u32 s3, s55, 2621440
  buffer_load_dwordx4 v2, s[4:7], s3 offen offset:0 nt lds
  v_lshlrev_b32 v196, 8, v32
  buffer_load_dwordx4 v3, s[4:7], s3 offen offset:1024 nt lds
  v_lshl_add_u32 v196, v33, 4, v196
  s_lshl_b32 s59, s52, 9
  buffer_load_dwordx4 v4, s[4:7], s3 offen offset:2048 nt lds
  s_add_u32 s59, s59, 131072
  buffer_load_dwordx4 v5, s[4:7], s3 offen offset:3072 nt lds
  v_add_u32 v196, s59, v196
  v_and_b32 v197, 7, v1
  s_add_u32 m0, s56, 0
  s_add_u32 s3, s55, 3145728
  buffer_load_dwordx4 v2, s[4:7], s3 offen offset:0 nt lds
  v_lshlrev_b32 v197, 4, v197
  buffer_load_dwordx4 v3, s[4:7], s3 offen offset:1024 nt lds
  s_lshl_b32 s59, s52, 7
  s_add_u32 s59, s59, 131072
  buffer_load_dwordx4 v4, s[4:7], s3 offen offset:2048 nt lds
  v_add_u32 v197, s59, v197
  s_waitcnt lgkmcnt(0)
  buffer_load_dwordx4 v5, s[4:7], s3 offen offset:3072 nt lds
  v_mfma_f32_16x16x32_bf16 v[148:151], v[212:215], v[116:119], 0
  s_add_u32 m0, s56, 4096
  s_add_u32 s3, s55, 3670016
  buffer_load_dwordx4 v2, s[4:7], s3 offen offset:0 nt lds
  v_mfma_f32_16x16x32_bf16 v[152:155], v[216:219], v[116:119], 0
  v_mfma_f32_16x16x32_bf16 v[156:159], v[220:223], v[116:119], 0
  buffer_load_dwordx4 v3, s[4:7], s3 offen offset:1024 nt lds
  v_mfma_f32_16x16x32_bf16 v[160:163], v[224:227], v[116:119], 0
  buffer_load_dwordx4 v4, s[4:7], s3 offen offset:2048 nt lds
  v_mfma_f32_16x16x32_bf16 v[148:151], v[228:231], v[120:123], v[148:151]
  v_mfma_f32_16x16x32_bf16 v[152:155], v[232:235], v[120:123], v[152:155]
  buffer_load_dwordx4 v5, s[4:7], s3 offen offset:3072 nt lds
  v_mfma_f32_16x16x32_bf16 v[156:159], v[236:239], v[120:123], v[156:159]
  v_mfma_f32_16x16x32_bf16 v[160:163], v[240:243], v[120:123], v[160:163]
  s_mov_b32 exec_lo, 0x00030003
  s_mov_b32 exec_hi, 0x00030003
  s_nop 1
  ds_write_b128 v196, v[148:151] offset:0
  ds_write_b128 v196, v[152:155] offset:64
  s_nop 0
  ds_write_b128 v196, v[156:159] offset:128
  ds_write_b128 v196, v[160:163] offset:192
  s_mov_b64 exec, -1
  s_waitcnt lgkmcnt(0)
  s_barrier
  ds_read_b128 v[200:203], v197 offset:0
  ds_read_b128 v[204:207], v197 offset:512
  ds_read_b128 v[208:211], v197 offset:1024
  ds_read_b128 v[212:215], v197 offset:1536
  s_waitcnt lgkmcnt(0)
  v_pk_add_f32 v[200:201], v[200:201], v[204:205]
  v_pk_add_f32 v[202:203], v[202:203], v[206:207]
  v_pk_add_f32 v[208:209], v[208:209], v[212:213]
  v_pk_add_f32 v[210:211], v[210:211], v[214:215]
  v_pk_add_f32 v[220:221], v[200:201], v[208:209]
  v_pk_add_f32 v[222:223], v[202:203], v[210:211]
  buffer_store_dwordx4 v[220:223], v26, s[24:27], 0 offen sc1
  s_waitcnt vmcnt(17) lgkmcnt(0)
  ds_read_b128 a[48:51], v10 offset:20480
  ds_read_b128 a[52:55], v11 offset:20480
  ds_read_b128 a[56:59], v12 offset:20480
  ds_read_b128 a[60:63], v13 offset:20480
  s_mul_i32 s62, s52, 1792
  v_lshlrev_b32 v252, 4, v1
  v_lshlrev_b32 v253, 3, v1
  v_lshlrev_b32 v254, 2, v1
  v_mov_b32 v255, 0
  buffer_load_dwordx4 v[124:127], v252, s[36:39], s62 offen
  buffer_load_dwordx2 v[128:129], v253, s[36:39], s62 offen offset:1024
  buffer_load_dword v130, v254, s[36:39], s62 offen offset:1536
  buffer_load_dwordx4 v[132:135], v252, s[40:43], s62 offen
  buffer_load_dwordx2 v[136:137], v253, s[40:43], s62 offen offset:1024
  buffer_load_dword v138, v254, s[40:43], s62 offen offset:1536
  buffer_load_dwordx4 v[68:71], v252, s[44:47], s62 offen
  buffer_load_dwordx2 v[72:73], v253, s[44:47], s62 offen offset:1024
  buffer_load_dword v74, v254, s[44:47], s62 offen offset:1536
  buffer_load_ushort v77, v255, s[48:51], 0 offen
  s_waitcnt vmcnt(23) lgkmcnt(0)
  ds_read_b128 a[64:67], v10 offset:24576
  ds_read_b128 a[68:71], v11 offset:24576
  ds_read_b128 a[72:75], v12 offset:24576
  ds_read_b128 a[76:79], v13 offset:24576
  s_and_b32 s59, s2, 3
  s_lshl_b32 s59, s59, 6
  s_cmp_eq_u32 s52, 0
  s_cselect_b32 s59, s59, 0x1000
  v_lshl_add_u32 v236, v32, 2, s59
  buffer_load_dword v237, v236, s[28:31], 0 offen sc1
  s_add_u32 m0, s56, 8192
  s_add_u32 s3, s55, 4194304
  buffer_load_dwordx4 v2, s[4:7], s3 offen offset:0 nt lds
  buffer_load_dwordx4 v3, s[4:7], s3 offen offset:1024 nt lds
  buffer_load_dwordx4 v4, s[4:7], s3 offen offset:2048 nt lds
  buffer_load_dwordx4 v5, s[4:7], s3 offen offset:3072 nt lds
  s_waitcnt vmcnt(24) lgkmcnt(0)
  ds_read_b128 a[80:83], v10 offset:28672
  ds_read_b128 a[84:87], v11 offset:28672
  ds_read_b128 a[88:91], v12 offset:28672
  ds_read_b128 a[92:95], v13 offset:28672
  s_add_u32 m0, s56, 12288
  s_add_u32 s3, s55, 4718592
  buffer_load_dwordx4 v2, s[4:7], s3 offen offset:0 nt lds
  s_waitcnt vmcnt(6)
  v_lshlrev_b32 v40, 16, v124
  v_and_b32 v41, 0xffff0000, v124
  v_lshlrev_b32 v42, 16, v125
  v_and_b32 v43, 0xffff0000, v125
  v_lshlrev_b32 v44, 16, v126
  v_and_b32 v45, 0xffff0000, v126
  v_lshlrev_b32 v46, 16, v127
  v_and_b32 v47, 0xffff0000, v127
  v_lshlrev_b32 v48, 16, v128
  v_and_b32 v49, 0xffff0000, v128
  v_lshlrev_b32 v50, 16, v129
  v_and_b32 v51, 0xffff0000, v129
  v_lshlrev_b32 v52, 16, v130
  v_and_b32 v53, 0xffff0000, v130
  v_lshlrev_b32 v54, 16, v132
  v_and_b32 v55, 0xffff0000, v132
  v_lshlrev_b32 v56, 16, v133
  v_and_b32 v57, 0xffff0000, v133
  v_lshlrev_b32 v58, 16, v134
  v_and_b32 v59, 0xffff0000, v134
  v_lshlrev_b32 v60, 16, v135
  v_and_b32 v61, 0xffff0000, v135
  v_lshlrev_b32 v62, 16, v136
  v_and_b32 v63, 0xffff0000, v136
  v_lshlrev_b32 v64, 16, v137
  buffer_load_dwordx4 v3, s[4:7], s3 offen offset:1024 nt lds
  v_and_b32 v65, 0xffff0000, v137
  v_lshlrev_b32 v66, 16, v138
  v_and_b32 v67, 0xffff0000, v138
  v_lshlrev_b32 v77, 16, v77
  s_add_u32 s96, s97, 0
  v_pk_mul_f32 v[180:181], s[96:97], v[40:41] op_sel_hi:[0,1]
  v_pk_mul_f32 v[182:183], s[96:97], v[42:43] op_sel_hi:[0,1]
  v_pk_mul_f32 v[184:185], s[96:97], v[44:45] op_sel_hi:[0,1]
  v_pk_mul_f32 v[186:187], s[96:97], v[46:47] op_sel_hi:[0,1]
  v_pk_mul_f32 v[188:189], s[96:97], v[48:49] op_sel_hi:[0,1]
  v_pk_mul_f32 v[190:191], s[96:97], v[50:51] op_sel_hi:[0,1]
  v_pk_mul_f32 v[192:193], s[96:97], v[52:53] op_sel_hi:[0,1]
  v_cvt_pk_bf16_f32 v180, 0, v180
  v_cvt_pk_bf16_f32 v181, 0, v181
  v_cvt_pk_bf16_f32 v182, 0, v182
  v_cvt_pk_bf16_f32 v183, 0, v183
  v_cvt_pk_bf16_f32 v184, 0, v184
  v_cvt_pk_bf16_f32 v185, 0, v185
  v_cvt_pk_bf16_f32 v186, 0, v186
  v_cvt_pk_bf16_f32 v187, 0, v187
  v_cvt_pk_bf16_f32 v188, 0, v188
  v_cvt_pk_bf16_f32 v189, 0, v189
  v_cvt_pk_bf16_f32 v190, 0, v190
  v_cvt_pk_bf16_f32 v191, 0, v191
  v_cvt_pk_bf16_f32 v192, 0, v192
  v_cvt_pk_bf16_f32 v193, 0, v193
  buffer_load_dwordx4 v4, s[4:7], s3 offen offset:2048 nt lds
  v_pk_add_f32 v[196:197], v[54:55], v[180:181]
  v_pk_add_f32 v[198:199], v[56:57], v[182:183]
  v_pk_add_f32 v[200:201], v[58:59], v[184:185]
  v_pk_add_f32 v[202:203], v[60:61], v[186:187]
  v_pk_add_f32 v[204:205], v[62:63], v[188:189]
  v_pk_add_f32 v[206:207], v[64:65], v[190:191]
  v_pk_add_f32 v[208:209], v[66:67], v[192:193]
  v_cvt_pk_bf16_f32 v196, 0, v196
  v_cvt_pk_bf16_f32 v197, 0, v197
  v_cvt_pk_bf16_f32 v198, 0, v198
  v_cvt_pk_bf16_f32 v199, 0, v199
  v_cvt_pk_bf16_f32 v200, 0, v200
  v_cvt_pk_bf16_f32 v201, 0, v201
  v_cvt_pk_bf16_f32 v202, 0, v202
  v_cvt_pk_bf16_f32 v203, 0, v203
  v_cvt_pk_bf16_f32 v204, 0, v204
  v_cvt_pk_bf16_f32 v205, 0, v205
  v_cvt_pk_bf16_f32 v206, 0, v206
  v_cvt_pk_bf16_f32 v207, 0, v207
  v_cvt_pk_bf16_f32 v208, 0, v208
  v_cvt_pk_bf16_f32 v209, 0, v209
  v_pk_mul_f32 v[210:211], v[196:197], v[196:197]
  v_pk_mul_f32 v[212:213], v[198:199], v[198:199]
  v_pk_mul_f32 v[214:215], v[200:201], v[200:201]
  v_pk_mul_f32 v[216:217], v[202:203], v[202:203]
  v_pk_mul_f32 v[218:219], v[204:205], v[204:205]
  buffer_load_dwordx4 v5, s[4:7], s3 offen offset:3072 nt lds
  v_pk_mul_f32 v[220:221], v[206:207], v[206:207]
  v_pk_mul_f32 v[222:223], v[208:209], v[208:209]
  v_pk_fma_f32 v[210:211], v[210:211], s[100:101], v[36:37] op_sel_hi:[1,0,1]
  v_pk_fma_f32 v[212:213], v[212:213], s[100:101], v[36:37] op_sel_hi:[1,0,1]
  v_pk_fma_f32 v[214:215], v[214:215], s[100:101], v[36:37] op_sel_hi:[1,0,1]
  v_pk_fma_f32 v[216:217], v[216:217], s[100:101], v[36:37] op_sel_hi:[1,0,1]
  v_pk_fma_f32 v[218:219], v[218:219], s[100:101], v[36:37] op_sel_hi:[1,0,1]
  v_pk_fma_f32 v[220:221], v[220:221], s[100:101], v[36:37] op_sel_hi:[1,0,1]
  v_pk_fma_f32 v[222:223], v[222:223], s[100:101], v[36:37] op_sel_hi:[1,0,1]
  v_pk_mul_f32 v[210:211], v[210:211], v[196:197]
  v_pk_mul_f32 v[212:213], v[212:213], v[198:199]
  v_pk_mul_f32 v[214:215], v[214:215], v[200:201]
  v_pk_mul_f32 v[216:217], v[216:217], v[202:203]
  v_pk_mul_f32 v[218:219], v[218:219], v[204:205]
  v_pk_mul_f32 v[220:221], v[220:221], v[206:207]
  v_pk_mul_f32 v[222:223], v[222:223], v[208:209]
  v_exp_f32 v210, v210
  v_exp_f32 v211, v211
  v_exp_f32 v212, v212
  v_exp_f32 v213, v213
  v_exp_f32 v214, v214
  v_exp_f32 v215, v215
  v_exp_f32 v216, v216
  v_exp_f32 v217, v217
  v_exp_f32 v218, v218
  v_exp_f32 v219, v219
  v_exp_f32 v220, v220
  v_exp_f32 v221, v221
  v_exp_f32 v222, v222
  v_exp_f32 v223, v223
  v_pk_add_f32 v[210:211], v[210:211], v[38:39]
  v_pk_add_f32 v[212:213], v[212:213], v[38:39]
  v_pk_add_f32 v[214:215], v[214:215], v[38:39]
  v_pk_add_f32 v[216:217], v[216:217], v[38:39]
  v_pk_add_f32 v[218:219], v[218:219], v[38:39]
  v_pk_add_f32 v[220:221], v[220:221], v[38:39]
  v_pk_add_f32 v[222:223], v[222:223], v[38:39]
  v_rcp_f32 v210, v210
  v_rcp_f32 v211, v211
  v_rcp_f32 v212, v212
  v_rcp_f32 v213, v213
  v_rcp_f32 v214, v214
  v_rcp_f32 v215, v215
  v_rcp_f32 v216, v216
  v_rcp_f32 v217, v217
  v_rcp_f32 v218, v218
  v_rcp_f32 v219, v219
  v_rcp_f32 v220, v220
  v_rcp_f32 v221, v221
  v_rcp_f32 v222, v222
  v_rcp_f32 v223, v223
  v_pk_mul_f32 v[210:211], v[210:211], v[196:197]
  v_pk_mul_f32 v[212:213], v[212:213], v[198:199]
  v_pk_mul_f32 v[214:215], v[214:215], v[200:201]
  v_pk_mul_f32 v[216:217], v[216:217], v[202:203]
  v_pk_mul_f32 v[218:219], v[218:219], v[204:205]
  v_pk_mul_f32 v[220:221], v[220:221], v[206:207]
  v_pk_mul_f32 v[222:223], v[222:223], v[208:209]
  v_cvt_pk_bf16_f32 v196, v210, v211
  v_cvt_pk_bf16_f32 v197, v212, v213
  v_cvt_pk_bf16_f32 v198, v214, v215
  v_cvt_pk_bf16_f32 v199, v216, v217
  v_cvt_pk_bf16_f32 v200, v218, v219
  v_cvt_pk_bf16_f32 v201, v220, v221
  v_cvt_pk_bf16_f32 v202, v222, v223
  v_dot2c_f32_bf16 v84, v196, v68
  v_dot2c_f32_bf16 v84, v197, v69
  v_dot2c_f32_bf16 v84, v198, v70
  v_dot2c_f32_bf16 v84, v199, v71
  v_dot2c_f32_bf16 v84, v200, v72
  v_dot2c_f32_bf16 v84, v201, v73
  v_dot2c_f32_bf16 v84, v202, v74
  s_waitcnt vmcnt(24) lgkmcnt(0)
  s_cmp_lg_u32 s52, 0
  s_cbranch_scc1 L_chk_ok_1
  s_waitcnt vmcnt(8)
  v_cmp_ne_u32 vcc, 0x01010101, v237
  s_nop 3
  s_cbranch_vccz L_chk_ok_1
  s_mov_b32 s63, 20000
L_chk_lp_2:
  buffer_load_dword v237, v236, s[28:31], 0 offen sc1
  s_waitcnt vmcnt(0)
  v_cmp_ne_u32 vcc, 0x01010101, v237
  s_nop 3
  s_cbranch_vccz L_chk_ok_1
  s_sub_u32 s63, s63, 1
  s_cmp_lg_u32 s63, 0
  s_cbranch_scc1 L_chk_lp_2
L_chk_ok_1:
  s_barrier
  s_mov_b32 s66, 0x3db504f3
  s_mov_b32 s60, 0
  buffer_load_dwordx4 v[240:243], v78, s[24:27], s60 offen sc1
  s_mov_b32 s60, 4096
  buffer_load_dwordx4 v[244:247], v78, s[24:27], s60 offen sc1
  s_mov_b32 s60, 8192
  buffer_load_dwordx4 v[248:251], v78, s[24:27], s60 offen sc1
  s_mov_b32 s60, 12288
  buffer_load_dwordx4 v[252:255], v78, s[24:27], s60 offen sc1
  ds_read_b128 a[96:99], v10 offset:0
  ds_read_b128 a[100:103], v11 offset:0
  ds_read_b128 a[104:107], v12 offset:0
  ds_read_b128 a[108:111], v13 offset:0
  s_add_u32 m0, s56, 16384
  s_add_u32 s3, s55, 5242880
  buffer_load_dwordx4 v2, s[4:7], s3 offen offset:0 nt lds
  v_pk_add_f32 v[196:197], v[54:55], v[180:181] neg_lo:[0,1] neg_hi:[0,1]
  v_pk_add_f32 v[198:199], v[56:57], v[182:183] neg_lo:[0,1] neg_hi:[0,1]
  v_pk_add_f32 v[200:201], v[58:59], v[184:185] neg_lo:[0,1] neg_hi:[0,1]
  v_pk_add_f32 v[202:203], v[60:61], v[186:187] neg_lo:[0,1] neg_hi:[0,1]
  v_pk_add_f32 v[204:205], v[62:63], v[188:189] neg_lo:[0,1] neg_hi:[0,1]
  v_pk_add_f32 v[206:207], v[64:65], v[190:191] neg_lo:[0,1] neg_hi:[0,1]
  v_pk_add_f32 v[208:209], v[66:67], v[192:193] neg_lo:[0,1] neg_hi:[0,1]
  v_cvt_pk_bf16_f32 v196, 0, v196
  v_cvt_pk_bf16_f32 v197, 0, v197
  v_cvt_pk_bf16_f32 v198, 0, v198
  v_cvt_pk_bf16_f32 v199, 0, v199
  v_cvt_pk_bf16_f32 v200, 0, v200
  v_cvt_pk_bf16_f32 v201, 0, v201
  v_cvt_pk_bf16_f32 v202, 0, v202
  v_cvt_pk_bf16_f32 v203, 0, v203
  v_cvt_pk_bf16_f32 v204, 0, v204
  v_cvt_pk_bf16_f32 v205, 0, v205
  buffer_load_dwordx4 v3, s[4:7], s3 offen offset:1024 nt lds
  v_cvt_pk_bf16_f32 v206, 0, v206
  v_cvt_pk_bf16_f32 v207, 0, v207
  v_cvt_pk_bf16_f32 v208, 0, v208
  v_cvt_pk_bf16_f32 v209, 0, v209
  v_pk_mul_f32 v[210:211], v[196:197], v[196:197]
  v_pk_mul_f32 v[212:213], v[198:199], v[198:199]
  v_pk_mul_f32 v[214:215], v[200:201], v[200:201]
  v_pk_mul_f32 v[216:217], v[202:203], v[202:203]
  v_pk_mul_f32 v[218:219], v[204:205], v[204:205]
  v_pk_mul_f32 v[220:221], v[206:207], v[206:207]
  v_pk_mul_f32 v[222:223], v[208:209], v[208:209]
  v_pk_fma_f32 v[210:211], v[210:211], s[100:101], v[36:37] op_sel_hi:[1,0,1]
  v_pk_fma_f32 v[212:213], v[212:213], s[100:101], v[36:37] op_sel_hi:[1,0,1]
  v_pk_fma_f32 v[214:215], v[214:215], s[100:101], v[36:37] op_sel_hi:[1,0,1]
  v_pk_fma_f32 v[216:217], v[216:217], s[100:101], v[36:37] op_sel_hi:[1,0,1]
  v_pk_fma_f32 v[218:219], v[218:219], s[100:101], v[36:37] op_sel_hi:[1,0,1]
  v_pk_fma_f32 v[220:221], v[220:221], s[100:101], v[36:37] op_sel_hi:[1,0,1]
  buffer_load_dwordx4 v4, s[4:7], s3 offen offset:2048 nt lds
  v_pk_fma_f32 v[222:223], v[222:223], s[100:101], v[36:37] op_sel_hi:[1,0,1]
  v_pk_mul_f32 v[210:211], v[210:211], v[196:197]
  v_pk_mul_f32 v[212:213], v[212:213], v[198:199]
  v_pk_mul_f32 v[214:215], v[214:215], v[200:201]
  v_pk_mul_f32 v[216:217], v[216:217], v[202:203]
  v_pk_mul_f32 v[218:219], v[218:219], v[204:205]
  v_pk_mul_f32 v[220:221], v[220:221], v[206:207]
  v_pk_mul_f32 v[222:223], v[222:223], v[208:209]
  v_exp_f32 v210, v210
  v_exp_f32 v211, v211
  v_exp_f32 v212, v212
  v_exp_f32 v213, v213
  v_exp_f32 v214, v214
  v_exp_f32 v215, v215
  v_exp_f32 v216, v216
  v_exp_f32 v217, v217
  v_exp_f32 v218, v218
  buffer_load_dwordx4 v5, s[4:7], s3 offen offset:3072 nt lds
  v_exp_f32 v219, v219
  v_exp_f32 v220, v220
  v_exp_f32 v221, v221
  v_exp_f32 v222, v222
  v_exp_f32 v223, v223
  v_pk_add_f32 v[210:211], v[210:211], v[38:39]
  v_pk_add_f32 v[212:213], v[212:213], v[38:39]
  v_pk_add_f32 v[214:215], v[214:215], v[38:39]
  v_pk_add_f32 v[216:217], v[216:217], v[38:39]
  v_pk_add_f32 v[218:219], v[218:219], v[38:39]
  v_pk_add_f32 v[220:221], v[220:221], v[38:39]
  v_pk_add_f32 v[222:223], v[222:223], v[38:39]
  v_rcp_f32 v210, v210
  v_rcp_f32 v211, v211
  v_rcp_f32 v212, v212
  v_rcp_f32 v213, v213
  v_rcp_f32 v214, v214
  v_rcp_f32 v215, v215
  v_rcp_f32 v216, v216
  v_rcp_f32 v217, v217
  v_rcp_f32 v218, v218
  v_rcp_f32 v219, v219
  v_rcp_f32 v220, v220
  v_rcp_f32 v221, v221
  v_rcp_f32 v222, v222
  v_rcp_f32 v223, v223
  v_pk_mul_f32 v[210:211], v[210:211], v[196:197]
  v_pk_mul_f32 v[212:213], v[212:213], v[198:199]
  v_pk_mul_f32 v[214:215], v[214:215], v[200:201]
  v_pk_mul_f32 v[216:217], v[216:217], v[202:203]
  v_pk_mul_f32 v[218:219], v[218:219], v[204:205]
  v_pk_mul_f32 v[220:221], v[220:221], v[206:207]
  v_pk_mul_f32 v[222:223], v[222:223], v[208:209]
  v_cvt_pk_bf16_f32 v196, v210, v211
  v_cvt_pk_bf16_f32 v197, v212, v213
  v_cvt_pk_bf16_f32 v198, v214, v215
  v_cvt_pk_bf16_f32 v199, v216, v217
  v_cvt_pk_bf16_f32 v200, v218, v219
  v_cvt_pk_bf16_f32 v201, v220, v221
  v_cvt_pk_bf16_f32 v202, v222, v223
  v_dot2c_f32_bf16 v92, v196, v68
  v_dot2c_f32_bf16 v92, v197, v69
  v_dot2c_f32_bf16 v92, v198, v70
  v_dot2c_f32_bf16 v92, v199, v71
  v_dot2c_f32_bf16 v92, v200, v72
  v_dot2c_f32_bf16 v92, v201, v73
  v_dot2c_f32_bf16 v92, v202, v74
  s_waitcnt vmcnt(28) lgkmcnt(0)
  ds_read_b128 a[112:115], v10 offset:4096
  ds_read_b128 a[116:119], v11 offset:4096
  ds_read_b128 a[120:123], v12 offset:4096
  ds_read_b128 a[124:127], v13 offset:4096
  s_add_u32 m0, s56, 20480
  s_add_u32 s3, s55, 5767168
  buffer_load_dwordx4 v2, s[4:7], s3 offen offset:0 nt lds
  s_add_u32 s96, s97, 65536
  v_pk_mul_f32 v[180:181], s[96:97], v[40:41] op_sel_hi:[0,1]
  v_pk_mul_f32 v[182:183], s[96:97], v[42:43] op_sel_hi:[0,1]
  v_pk_mul_f32 v[184:185], s[96:97], v[44:45] op_sel_hi:[0,1]
  v_pk_mul_f32 v[186:187], s[96:97], v[46:47] op_sel_hi:[0,1]
  v_pk_mul_f32 v[188:189], s[96:97], v[48:49] op_sel_hi:[0,1]
  v_pk_mul_f32 v[190:191], s[96:97], v[50:51] op_sel_hi:[0,1]
  v_pk_mul_f32 v[192:193], s[96:97], v[52:53] op_sel_hi:[0,1]
  v_cvt_pk_bf16_f32 v180, 0, v180
  v_cvt_pk_bf16_f32 v181, 0, v181
  v_cvt_pk_bf16_f32 v182, 0, v182
  v_cvt_pk_bf16_f32 v183, 0, v183
  v_cvt_pk_bf16_f32 v184, 0, v184
  v_cvt_pk_bf16_f32 v185, 0, v185
  v_cvt_pk_bf16_f32 v186, 0, v186
  v_cvt_pk_bf16_f32 v187, 0, v187
  v_cvt_pk_bf16_f32 v188, 0, v188
  v_cvt_pk_bf16_f32 v189, 0, v189
  v_cvt_pk_bf16_f32 v190, 0, v190
  v_cvt_pk_bf16_f32 v191, 0, v191
  v_cvt_pk_bf16_f32 v192, 0, v192
  buffer_load_dwordx4 v3, s[4:7], s3 offen offset:1024 nt lds
  v_cvt_pk_bf16_f32 v193, 0, v193
  v_pk_add_f32 v[196:197], v[54:55], v[180:181]
  v_pk_add_f32 v[198:199], v[56:57], v[182:183]
  v_pk_add_f32 v[200:201], v[58:59], v[184:185]
  v_pk_add_f32 v[202:203], v[60:61], v[186:187]
  v_pk_add_f32 v[204:205], v[62:63], v[188:189]
  v_pk_add_f32 v[206:207], v[64:65], v[190:191]
  v_pk_add_f32 v[208:209], v[66:67], v[192:193]
  v_cvt_pk_bf16_f32 v196, 0, v196
  v_cvt_pk_bf16_f32 v197, 0, v197
  v_cvt_pk_bf16_f32 v198, 0, v198
  v_cvt_pk_bf16_f32 v199, 0, v199
  v_cvt_pk_bf16_f32 v200, 0, v200
  v_cvt_pk_bf16_f32 v201, 0, v201
  v_cvt_pk_bf16_f32 v202, 0, v202
  v_cvt_pk_bf16_f32 v203, 0, v203
  v_cvt_pk_bf16_f32 v204, 0, v204
  v_cvt_pk_bf16_f32 v205, 0, v205
  v_cvt_pk_bf16_f32 v206, 0, v206
  v_cvt_pk_bf16_f32 v207, 0, v207
  v_cvt_pk_bf16_f32 v208, 0, v208
  buffer_load_dwordx4 v4, s[4:7], s3 offen offset:2048 nt lds
  v_cvt_pk_bf16_f32 v209, 0, v209
  v_pk_mul_f32 v[210:211], v[196:197], v[196:197]
  v_pk_mul_f32 v[212:213], v[198:199], v[198:199]
  v_pk_mul_f32 v[214:215], v[200:201], v[200:201]
  v_pk_mul_f32 v[216:217], v[202:203], v[202:203]
  v_pk_mul_f32 v[218:219], v[204:205], v[204:205]
  v_pk_mul_f32 v[220:221], v[206:207], v[206:207]
  v_pk_mul_f32 v[222:223], v[208:209], v[208:209]
  v_pk_fma_f32 v[210:211], v[210:211], s[100:101], v[36:37] op_sel_hi:[1,0,1]
  v_pk_fma_f32 v[212:213], v[212:213], s[100:101], v[36:37] op_sel_hi:[1,0,1]
  v_pk_fma_f32 v[214:215], v[214:215], s[100:101], v[36:37] op_sel_hi:[1,0,1]
  v_pk_fma_f32 v[216:217], v[216:217], s[100:101], v[36:37] op_sel_hi:[1,0,1]
  v_pk_fma_f32 v[218:219], v[218:219], s[100:101], v[36:37] op_sel_hi:[1,0,1]
  v_pk_fma_f32 v[220:221], v[220:221], s[100:101], v[36:37] op_sel_hi:[1,0,1]
  v_pk_fma_f32 v[222:223], v[222:223], s[100:101], v[36:37] op_sel_hi:[1,0,1]
  v_pk_mul_f32 v[210:211], v[210:211], v[196:197]
  v_pk_mul_f32 v[212:213], v[212:213], v[198:199]
  v_pk_mul_f32 v[214:215], v[214:215], v[200:201]
  v_pk_mul_f32 v[216:217], v[216:217], v[202:203]
  v_pk_mul_f32 v[218:219], v[218:219], v[204:205]
  v_pk_mul_f32 v[220:221], v[220:221], v[206:207]
  buffer_load_dwordx4 v5, s[4:7], s3 offen offset:3072 nt lds
  v_pk_mul_f32 v[222:223], v[222:223], v[208:209]
  v_exp_f32 v210, v210
  v_exp_f32 v211, v211
  v_exp_f32 v212, v212
  v_exp_f32 v213, v213
  v_exp_f32 v214, v214
  v_exp_f32 v215, v215
  v_exp_f32 v216, v216
  v_exp_f32 v217, v217
  v_exp_f32 v218, v218
  v_exp_f32 v219, v219
  v_exp_f32 v220, v220
  v_exp_f32 v221, v221
  v_exp_f32 v222, v222
  v_exp_f32 v223, v223
  v_pk_add_f32 v[210:211], v[210:211], v[38:39]
  v_pk_add_f32 v[212:213], v[212:213], v[38:39]
  v_pk_add_f32 v[214:215], v[214:215], v[38:39]
  v_pk_add_f32 v[216:217], v[216:217], v[38:39]
  v_pk_add_f32 v[218:219], v[218:219], v[38:39]
  v_pk_add_f32 v[220:221], v[220:221], v[38:39]
  v_pk_add_f32 v[222:223], v[222:223], v[38:39]
  v_rcp_f32 v210, v210
  v_rcp_f32 v211, v211
  v_rcp_f32 v212, v212
  v_rcp_f32 v213, v213
  v_rcp_f32 v214, v214
  v_rcp_f32 v215, v215
  v_rcp_f32 v216, v216
  v_rcp_f32 v217, v217
  v_rcp_f32 v218, v218
  v_rcp_f32 v219, v219
  v_rcp_f32 v220, v220
  v_rcp_f32 v221, v221
  v_rcp_f32 v222, v222
  v_rcp_f32 v223, v223
  v_pk_mul_f32 v[210:211], v[210:211], v[196:197]
  v_pk_mul_f32 v[212:213], v[212:213], v[198:199]
  v_pk_mul_f32 v[214:215], v[214:215], v[200:201]
  v_pk_mul_f32 v[216:217], v[216:217], v[202:203]
  v_pk_mul_f32 v[218:219], v[218:219], v[204:205]
  v_pk_mul_f32 v[220:221], v[220:221], v[206:207]
  v_pk_mul_f32 v[222:223], v[222:223], v[208:209]
  v_cvt_pk_bf16_f32 v196, v210, v211
  v_cvt_pk_bf16_f32 v197, v212, v213
  v_cvt_pk_bf16_f32 v198, v214, v215
  v_cvt_pk_bf16_f32 v199, v216, v217
  v_cvt_pk_bf16_f32 v200, v218, v219
  v_cvt_pk_bf16_f32 v201, v220, v221
  v_cvt_pk_bf16_f32 v202, v222, v223
  v_dot2c_f32_bf16 v85, v196, v68
  v_dot2c_f32_bf16 v85, v197, v69
  v_dot2c_f32_bf16 v85, v198, v70
  v_dot2c_f32_bf16 v85, v199, v71
  v_dot2c_f32_bf16 v85, v200, v72
  v_dot2c_f32_bf16 v85, v201, v73
  v_dot2c_f32_bf16 v85, v202, v74
  s_waitcnt vmcnt(16) lgkmcnt(0)
  ds_read_b128 a[128:131], v10 offset:8192
  ds_read_b128 a[132:135], v11 offset:8192
  ds_read_b128 a[136:139], v12 offset:8192
  ds_read_b128 a[140:143], v13 offset:8192
  s_add_u32 m0, s56, 24576
  s_add_u32 s3, s55, 6291456
  buffer_load_dwordx4 v2, s[4:7], s3 offen offset:0 nt lds
  v_pk_add_f32 v[196:197], v[54:55], v[180:181] neg_lo:[0,1] neg_hi:[0,1]
  v_pk_add_f32 v[198:199], v[56:57], v[182:183] neg_lo:[0,1] neg_hi:[0,1]
  v_pk_add_f32 v[200:201], v[58:59], v[184:185] neg_lo:[0,1] neg_hi:[0,1]
  v_pk_add_f32 v[202:203], v[60:61], v[186:187] neg_lo:[0,1] neg_hi:[0,1]
  v_pk_add_f32 v[204:205], v[62:63], v[188:189] neg_lo:[0,1] neg_hi:[0,1]
  v_pk_add_f32 v[206:207], v[64:65], v[190:191] neg_lo:[0,1] neg_hi:[0,1]
  v_pk_add_f32 v[208:209], v[66:67], v[192:193] neg_lo:[0,1] neg_hi:[0,1]
  v_cvt_pk_bf16_f32 v196, 0, v196
  v_cvt_pk_bf16_f32 v197, 0, v197
  v_cvt_pk_bf16_f32 v198, 0, v198
  v_cvt_pk_bf16_f32 v199, 0, v199
  v_cvt_pk_bf16_f32 v200, 0, v200
  v_cvt_pk_bf16_f32 v201, 0, v201
  v_cvt_pk_bf16_f32 v202, 0, v202
  v_cvt_pk_bf16_f32 v203, 0, v203
  v_cvt_pk_bf16_f32 v204, 0, v204
  v_cvt_pk_bf16_f32 v205, 0, v205
  buffer_load_dwordx4 v3, s[4:7], s3 offen offset:1024 nt lds
  v_cvt_pk_bf16_f32 v206, 0, v206
  v_cvt_pk_bf16_f32 v207, 0, v207
  v_cvt_pk_bf16_f32 v208, 0, v208
  v_cvt_pk_bf16_f32 v209, 0, v209
  v_pk_mul_f32 v[210:211], v[196:197], v[196:197]
  v_pk_mul_f32 v[212:213], v[198:199], v[198:199]
  v_pk_mul_f32 v[214:215], v[200:201], v[200:201]
  v_pk_mul_f32 v[216:217], v[202:203], v[202:203]
  v_pk_mul_f32 v[218:219], v[204:205], v[204:205]
  v_pk_mul_f32 v[220:221], v[206:207], v[206:207]
  v_pk_mul_f32 v[222:223], v[208:209], v[208:209]
  v_pk_fma_f32 v[210:211], v[210:211], s[100:101], v[36:37] op_sel_hi:[1,0,1]
  v_pk_fma_f32 v[212:213], v[212:213], s[100:101], v[36:37] op_sel_hi:[1,0,1]
  v_pk_fma_f32 v[214:215], v[214:215], s[100:101], v[36:37] op_sel_hi:[1,0,1]
  v_pk_fma_f32 v[216:217], v[216:217], s[100:101], v[36:37] op_sel_hi:[1,0,1]
  v_pk_fma_f32 v[218:219], v[218:219], s[100:101], v[36:37] op_sel_hi:[1,0,1]
  v_pk_fma_f32 v[220:221], v[220:221], s[100:101], v[36:37] op_sel_hi:[1,0,1]
  buffer_load_dwordx4 v4, s[4:7], s3 offen offset:2048 nt lds
  v_pk_fma_f32 v[222:223], v[222:223], s[100:101], v[36:37] op_sel_hi:[1,0,1]
  v_pk_mul_f32 v[210:211], v[210:211], v[196:197]
  v_pk_mul_f32 v[212:213], v[212:213], v[198:199]
  v_pk_mul_f32 v[214:215], v[214:215], v[200:201]
  v_pk_mul_f32 v[216:217], v[216:217], v[202:203]
  v_pk_mul_f32 v[218:219], v[218:219], v[204:205]
  v_pk_mul_f32 v[220:221], v[220:221], v[206:207]
  v_pk_mul_f32 v[222:223], v[222:223], v[208:209]
  v_exp_f32 v210, v210
  v_exp_f32 v211, v211
  v_exp_f32 v212, v212
  v_exp_f32 v213, v213
  v_exp_f32 v214, v214
  v_exp_f32 v215, v215
  v_exp_f32 v216, v216
  v_exp_f32 v217, v217
  v_exp_f32 v218, v218
  buffer_load_dwordx4 v5, s[4:7], s3 offen offset:3072 nt lds
  v_exp_f32 v219, v219
  v_exp_f32 v220, v220
  v_exp_f32 v221, v221
  v_exp_f32 v222, v222
  v_exp_f32 v223, v223
  v_pk_add_f32 v[210:211], v[210:211], v[38:39]
  v_pk_add_f32 v[212:213], v[212:213], v[38:39]
  v_pk_add_f32 v[214:215], v[214:215], v[38:39]
  v_pk_add_f32 v[216:217], v[216:217], v[38:39]
  v_pk_add_f32 v[218:219], v[218:219], v[38:39]
  v_pk_add_f32 v[220:221], v[220:221], v[38:39]
  v_pk_add_f32 v[222:223], v[222:223], v[38:39]
  v_rcp_f32 v210, v210
  v_rcp_f32 v211, v211
  v_rcp_f32 v212, v212
  v_rcp_f32 v213, v213
  v_rcp_f32 v214, v214
  v_rcp_f32 v215, v215
  v_rcp_f32 v216, v216
  v_rcp_f32 v217, v217
  v_rcp_f32 v218, v218
  v_rcp_f32 v219, v219
  v_rcp_f32 v220, v220
  v_rcp_f32 v221, v221
  v_rcp_f32 v222, v222
  v_rcp_f32 v223, v223
  v_pk_mul_f32 v[210:211], v[210:211], v[196:197]
  v_pk_mul_f32 v[212:213], v[212:213], v[198:199]
  v_pk_mul_f32 v[214:215], v[214:215], v[200:201]
  v_pk_mul_f32 v[216:217], v[216:217], v[202:203]
  v_pk_mul_f32 v[218:219], v[218:219], v[204:205]
  v_pk_mul_f32 v[220:221], v[220:221], v[206:207]
  v_pk_mul_f32 v[222:223], v[222:223], v[208:209]
  v_cvt_pk_bf16_f32 v196, v210, v211
  v_cvt_pk_bf16_f32 v197, v212, v213
  v_cvt_pk_bf16_f32 v198, v214, v215
  v_cvt_pk_bf16_f32 v199, v216, v217
  v_cvt_pk_bf16_f32 v200, v218, v219
  v_cvt_pk_bf16_f32 v201, v220, v221
  v_cvt_pk_bf16_f32 v202, v222, v223
  v_dot2c_f32_bf16 v93, v196, v68
  v_dot2c_f32_bf16 v93, v197, v69
  v_dot2c_f32_bf16 v93, v198, v70
  v_dot2c_f32_bf16 v93, v199, v71
  v_dot2c_f32_bf16 v93, v200, v72
  v_dot2c_f32_bf16 v93, v201, v73
  v_dot2c_f32_bf16 v93, v202, v74
  s_waitcnt vmcnt(16) lgkmcnt(0)
  ds_read_b128 a[144:147], v10 offset:12288
  ds_read_b128 a[148:151], v11 offset:12288
  ds_read_b128 a[152:155], v12 offset:12288
  ds_read_b128 a[156:159], v13 offset:12288
  s_add_u32 m0, s56, 28672
  s_add_u32 s3, s55, 6815744
  buffer_load_dwordx4 v2, s[4:7], s3 offen offset:0 nt lds
  s_add_u32 s96, s97, 131072
  v_pk_mul_f32 v[180:181], s[96:97], v[40:41] op_sel_hi:[0,1]
  v_pk_mul_f32 v[182:183], s[96:97], v[42:43] op_sel_hi:[0,1]
  v_pk_mul_f32 v[184:185], s[96:97], v[44:45] op_sel_hi:[0,1]
  v_pk_mul_f32 v[186:187], s[96:97], v[46:47] op_sel_hi:[0,1]
  v_pk_mul_f32 v[188:189], s[96:97], v[48:49] op_sel_hi:[0,1]
  v_pk_mul_f32 v[190:191], s[96:97], v[50:51] op_sel_hi:[0,1]
  v_pk_mul_f32 v[192:193], s[96:97], v[52:53] op_sel_hi:[0,1]
  v_cvt_pk_bf16_f32 v180, 0, v180
  v_cvt_pk_bf16_f32 v181, 0, v181
  v_cvt_pk_bf16_f32 v182, 0, v182
  v_cvt_pk_bf16_f32 v183, 0, v183
  v_cvt_pk_bf16_f32 v184, 0, v184
  v_cvt_pk_bf16_f32 v185, 0, v185
  v_cvt_pk_bf16_f32 v186, 0, v186
  v_cvt_pk_bf16_f32 v187, 0, v187
  v_cvt_pk_bf16_f32 v188, 0, v188
  v_cvt_pk_bf16_f32 v189, 0, v189
  v_cvt_pk_bf16_f32 v190, 0, v190
  v_cvt_pk_bf16_f32 v191, 0, v191
  v_cvt_pk_bf16_f32 v192, 0, v192
  buffer_load_dwordx4 v3, s[4:7], s3 offen offset:1024 nt lds
  v_cvt_pk_bf16_f32 v193, 0, v193
  v_pk_add_f32 v[196:197], v[54:55], v[180:181]
  v_pk_add_f32 v[198:199], v[56:57], v[182:183]
  v_pk_add_f32 v[200:201], v[58:59], v[184:185]
  v_pk_add_f32 v[202:203], v[60:61], v[186:187]
  v_pk_add_f32 v[204:205], v[62:63], v[188:189]
  v_pk_add_f32 v[206:207], v[64:65], v[190:191]
  v_pk_add_f32 v[208:209], v[66:67], v[192:193]
  v_cvt_pk_bf16_f32 v196, 0, v196
  v_cvt_pk_bf16_f32 v197, 0, v197
  v_cvt_pk_bf16_f32 v198, 0, v198
  v_cvt_pk_bf16_f32 v199, 0, v199
  v_cvt_pk_bf16_f32 v200, 0, v200
  v_cvt_pk_bf16_f32 v201, 0, v201
  v_cvt_pk_bf16_f32 v202, 0, v202
  v_cvt_pk_bf16_f32 v203, 0, v203
  v_cvt_pk_bf16_f32 v204, 0, v204
  v_cvt_pk_bf16_f32 v205, 0, v205
  v_cvt_pk_bf16_f32 v206, 0, v206
  v_cvt_pk_bf16_f32 v207, 0, v207
  v_cvt_pk_bf16_f32 v208, 0, v208
  buffer_load_dwordx4 v4, s[4:7], s3 offen offset:2048 nt lds
  v_cvt_pk_bf16_f32 v209, 0, v209
  v_pk_mul_f32 v[210:211], v[196:197], v[196:197]
  v_pk_mul_f32 v[212:213], v[198:199], v[198:199]
  v_pk_mul_f32 v[214:215], v[200:201], v[200:201]
  v_pk_mul_f32 v[216:217], v[202:203], v[202:203]
  v_pk_mul_f32 v[218:219], v[204:205], v[204:205]
  v_pk_mul_f32 v[220:221], v[206:207], v[206:207]
  v_pk_mul_f32 v[222:223], v[208:209], v[208:209]
  v_pk_fma_f32 v[210:211], v[210:211], s[100:101], v[36:37] op_sel_hi:[1,0,1]
  v_pk_fma_f32 v[212:213], v[212:213], s[100:101], v[36:37] op_sel_hi:[1,0,1]
  v_pk_fma_f32 v[214:215], v[214:215], s[100:101], v[36:37] op_sel_hi:[1,0,1]
  v_pk_fma_f32 v[216:217], v[216:217], s[100:101], v[36:37] op_sel_hi:[1,0,1]
  v_pk_fma_f32 v[218:219], v[218:219], s[100:101], v[36:37] op_sel_hi:[1,0,1]
  v_pk_fma_f32 v[220:221], v[220:221], s[100:101], v[36:37] op_sel_hi:[1,0,1]
  v_pk_fma_f32 v[222:223], v[222:223], s[100:101], v[36:37] op_sel_hi:[1,0,1]
  v_pk_mul_f32 v[210:211], v[210:211], v[196:197]
  v_pk_mul_f32 v[212:213], v[212:213], v[198:199]
  v_pk_mul_f32 v[214:215], v[214:215], v[200:201]
  v_pk_mul_f32 v[216:217], v[216:217], v[202:203]
  v_pk_mul_f32 v[218:219], v[218:219], v[204:205]
  v_pk_mul_f32 v[220:221], v[220:221], v[206:207]
  buffer_load_dwordx4 v5, s[4:7], s3 offen offset:3072 nt lds
  v_pk_mul_f32 v[222:223], v[222:223], v[208:209]
  v_exp_f32 v210, v210
  v_exp_f32 v211, v211
  v_exp_f32 v212, v212
  v_exp_f32 v213, v213
  v_exp_f32 v214, v214
  v_exp_f32 v215, v215
  v_exp_f32 v216, v216
  v_exp_f32 v217, v217
  v_exp_f32 v218, v218
  v_exp_f32 v219, v219
  v_exp_f32 v220, v220
  v_exp_f32 v221, v221
  v_exp_f32 v222, v222
  v_exp_f32 v223, v223
  v_pk_add_f32 v[210:211], v[210:211], v[38:39]
  v_pk_add_f32 v[212:213], v[212:213], v[38:39]
  v_pk_add_f32 v[214:215], v[214:215], v[38:39]
  v_pk_add_f32 v[216:217], v[216:217], v[38:39]
  v_pk_add_f32 v[218:219], v[218:219], v[38:39]
  v_pk_add_f32 v[220:221], v[220:221], v[38:39]
  v_pk_add_f32 v[222:223], v[222:223], v[38:39]
  v_rcp_f32 v210, v210
  v_rcp_f32 v211, v211
  v_rcp_f32 v212, v212
  v_rcp_f32 v213, v213
  v_rcp_f32 v214, v214
  v_rcp_f32 v215, v215
  v_rcp_f32 v216, v216
  v_rcp_f32 v217, v217
  v_rcp_f32 v218, v218
  v_rcp_f32 v219, v219
  v_rcp_f32 v220, v220
  v_rcp_f32 v221, v221
  v_rcp_f32 v222, v222
  v_rcp_f32 v223, v223
  v_pk_mul_f32 v[210:211], v[210:211], v[196:197]
  v_pk_mul_f32 v[212:213], v[212:213], v[198:199]
  v_pk_mul_f32 v[214:215], v[214:215], v[200:201]
  v_pk_mul_f32 v[216:217], v[216:217], v[202:203]
  v_pk_mul_f32 v[218:219], v[218:219], v[204:205]
  v_pk_mul_f32 v[220:221], v[220:221], v[206:207]
  v_pk_mul_f32 v[222:223], v[222:223], v[208:209]
  v_cvt_pk_bf16_f32 v196, v210, v211
  v_cvt_pk_bf16_f32 v197, v212, v213
  v_cvt_pk_bf16_f32 v198, v214, v215
  v_cvt_pk_bf16_f32 v199, v216, v217
  v_cvt_pk_bf16_f32 v200, v218, v219
  v_cvt_pk_bf16_f32 v201, v220, v221
  v_cvt_pk_bf16_f32 v202, v222, v223
  v_dot2c_f32_bf16 v86, v196, v68
  v_dot2c_f32_bf16 v86, v197, v69
  v_dot2c_f32_bf16 v86, v198, v70
  v_dot2c_f32_bf16 v86, v199, v71
  v_dot2c_f32_bf16 v86, v200, v72
  v_dot2c_f32_bf16 v86, v201, v73
  v_dot2c_f32_bf16 v86, v202, v74
  s_waitcnt vmcnt(12) lgkmcnt(0)
  ds_read_b128 a[160:163], v10 offset:16384
  ds_read_b128 a[164:167], v11 offset:16384
  ds_read_b128 a[168:171], v12 offset:16384
  ds_read_b128 a[172:175], v13 offset:16384
  s_add_u32 m0, s56, 0
  s_add_u32 s3, s55, 7340032
  buffer_load_dwordx4 v2, s[4:7], s3 offen offset:0 nt lds
  buffer_load_dwordx4 v3, s[4:7], s3 offen offset:1024 nt lds
  buffer_load_dwordx4 v4, s[4:7], s3 offen offset:2048 nt lds
  buffer_load_dwordx4 v5, s[4:7], s3 offen offset:3072 nt lds
  s_waitcnt vmcnt(20)
  v_max3_u32 v196, v240, v241, v242
  v_max3_u32 v196, v196, v243, v244
  v_max3_u32 v196, v196, v245, v246
  v_max3_u32 v196, v196, v247, v248
  v_max3_u32 v196, v196, v249, v250
  v_max3_u32 v196, v196, v251, v252
  v_max3_u32 v196, v196, v253, v254
  v_max_u32 v196, v196, v255
  v_cmp_eq_u32 vcc, -1, v196
  s_nop 3
  s_cbranch_vccz L_qg_ok_3
  s_mov_b32 s63, 20000
L_qg_poll_4:
  s_mov_b32 s60, 0
  buffer_load_dwordx4 v[240:243], v78, s[24:27], s60 offen sc1
  s_mov_b32 s60, 4096
  buffer_load_dwordx4 v[244:247], v78, s[24:27], s60 offen sc1
  s_mov_b32 s60, 8192
  buffer_load_dwordx4 v[248:251], v78, s[24:27], s60 offen sc1
  s_mov_b32 s60, 12288
  buffer_load_dwordx4 v[252:255], v78, s[24:27], s60 offen sc1
  s_waitcnt vmcnt(0)
  v_max3_u32 v196, v240, v241, v242
  v_max3_u32 v196, v196, v243, v244
  v_max3_u32 v196, v196, v245, v246
  v_max3_u32 v196, v196, v247, v248
  v_max3_u32 v196, v196, v249, v250
  v_max3_u32 v196, v196, v251, v252
  v_max3_u32 v196, v196, v253, v254
  v_max_u32 v196, v196, v255
  v_cmp_eq_u32 vcc, -1, v196
  s_mov_b64 exec, vcc
  s_nop 2
  s_cbranch_execz L_qg_poll_done_5
  s_sub_u32 s63, s63, 1
  s_cmp_lg_u32 s63, 0
  s_cbranch_scc1 L_qg_poll_4
L_qg_poll_done_5:
  s_mov_b64 exec, -1
L_qg_ok_3:
  v_pk_add_f32 v[240:241], v[240:241], v[244:245]
  v_pk_add_f32 v[242:243], v[242:243], v[246:247]
  v_pk_add_f32 v[248:249], v[248:249], v[252:253]
  v_pk_add_f32 v[250:251], v[250:251], v[254:255]
  v_pk_add_f32 v[240:241], v[240:241], v[248:249]
  v_pk_add_f32 v[242:243], v[242:243], v[250:251]
  v_cvt_pk_bf16_f32 v244, v240, v241
  v_cvt_pk_bf16_f32 v245, v242, v243
  v_lshlrev_b32 v196, 3, v0
  v_add_u32 v196, 133120, v196
  ds_write_b64 v196, v[244:245]
  s_waitcnt lgkmcnt(0)
  s_barrier
  ds_read_b128 v[164:167], v79 offset:0
  ds_read_b128 v[168:171], v79 offset:64
  ds_read_b128 v[172:175], v79 offset:128
  ds_read_b128 v[176:179], v79 offset:192
  s_waitcnt lgkmcnt(0)
  v_mfma_f32_16x16x32_bf16 v[100:103], a[0:3], v[164:167], 0
  s_add_u32 m0, s56, 4096
  s_add_u32 s3, s55, 7864320
  buffer_load_dwordx4 v2, s[4:7], s3 offen offset:0 nt lds
  v_mfma_f32_16x16x32_bf16 v[104:107], a[16:19], v[164:167], 0
  v_mfma_f32_16x16x32_bf16 v[100:103], a[4:7], v[168:171], v[100:103]
  v_mfma_f32_16x16x32_bf16 v[104:107], a[20:23], v[168:171], v[104:107]
  v_mfma_f32_16x16x32_bf16 v[100:103], a[8:11], v[172:175], v[100:103]
  v_mfma_f32_16x16x32_bf16 v[104:107], a[24:27], v[172:175], v[104:107]
  v_mfma_f32_16x16x32_bf16 v[100:103], a[12:15], v[176:179], v[100:103]
  v_mfma_f32_16x16x32_bf16 v[104:107], a[28:31], v[176:179], v[104:107]
  v_mfma_f32_16x16x32_bf16 v[108:111], a[32:35], v[164:167], 0
  s_nop 5
  v_cvt_pk_bf16_f32 v100, 0, v100
  v_cvt_pk_bf16_f32 v101, 0, v101
  v_mfma_f32_16x16x32_bf16 v[112:115], a[48:51], v[164:167], 0
  v_cvt_pk_bf16_f32 v102, 0, v102
  buffer_load_dwordx4 v3, s[4:7], s3 offen offset:1024 nt lds
  v_cvt_pk_bf16_f32 v103, 0, v103
  v_cvt_pk_bf16_f32 v104, 0, v104
  v_mfma_f32_16x16x32_bf16 v[108:111], a[36:39], v[168:171], v[108:111]
  v_cvt_pk_bf16_f32 v105, 0, v105
  v_cvt_pk_bf16_f32 v106, 0, v106
  v_cvt_pk_bf16_f32 v107, 0, v107
  v_mfma_f32_16x16x32_bf16 v[112:115], a[52:55], v[168:171], v[112:115]
  v_pk_mul_f32 v[100:101], s[66:67], v[100:101] op_sel_hi:[0,1]
  v_pk_mul_f32 v[102:103], s[66:67], v[102:103] op_sel_hi:[0,1]
  v_mfma_f32_16x16x32_bf16 v[108:111], a[40:43], v[172:175], v[108:111]
  v_pk_mul_f32 v[104:105], s[66:67], v[104:105] op_sel_hi:[0,1]
  v_pk_mul_f32 v[106:107], s[66:67], v[106:107] op_sel_hi:[0,1]
  v_cvt_pk_bf16_f32 v100, 0, v100
  buffer_load_dwordx4 v4, s[4:7], s3 offen offset:2048 nt lds
  v_mfma_f32_16x16x32_bf16 v[112:115], a[56:59], v[172:175], v[112:115]
  v_cvt_pk_bf16_f32 v101, 0, v101
  v_cvt_pk_bf16_f32 v102, 0, v102
  v_cvt_pk_bf16_f32 v103, 0, v103
  v_mfma_f32_16x16x32_bf16 v[108:111], a[44:47], v[176:179], v[108:111]
  v_cvt_pk_bf16_f32 v104, 0, v104
  v_cvt_pk_bf16_f32 v105, 0, v105
  v_mfma_f32_16x16x32_bf16 v[112:115], a[60:63], v[176:179], v[112:115]
  v_cvt_pk_bf16_f32 v106, 0, v106
  v_cvt_pk_bf16_f32 v107, 0, v107
  v_max_f32 v75, v100, v101
  v_max3_f32 v75, v75, v102, v103
  v_max3_f32 v75, v75, v104, v105
  buffer_load_dwordx4 v5, s[4:7], s3 offen offset:3072 nt lds
  v_max3_f32 v75, v75, v106, v107
  v_mfma_f32_16x16x32_bf16 v[116:119], a[64:67], v[164:167], 0
  v_cvt_pk_bf16_f32 v108, 0, v108
  v_cvt_pk_bf16_f32 v109, 0, v109
  v_mfma_f32_16x16x32_bf16 v[120:123], a[80:83], v[164:167], 0
  v_cvt_pk_bf16_f32 v110, 0, v110
  v_cvt_pk_bf16_f32 v111, 0, v111
  v_cvt_pk_bf16_f32 v112, 0, v112
  v_mfma_f32_16x16x32_bf16 v[116:119], a[68:71], v[168:171], v[116:119]
  v_cvt_pk_bf16_f32 v113, 0, v113
  v_cvt_pk_bf16_f32 v114, 0, v114
  v_cvt_pk_bf16_f32 v115, 0, v115
  v_mfma_f32_16x16x32_bf16 v[120:123], a[84:87], v[168:171], v[120:123]
  s_add_u32 m0, s56, 8192
  s_add_u32 s3, s55, 0
  buffer_load_dwordx4 v6, s[8:11], s3 offen offset:0 nt lds
  v_pk_mul_f32 v[108:109], s[66:67], v[108:109] op_sel_hi:[0,1]
  v_pk_mul_f32 v[110:111], s[66:67], v[110:111] op_sel_hi:[0,1]
  v_mfma_f32_16x16x32_bf16 v[116:119], a[72:75], v[172:175], v[116:119]
  v_pk_mul_f32 v[112:113], s[66:67], v[112:113] op_sel_hi:[0,1]
  v_pk_mul_f32 v[114:115], s[66:67], v[114:115] op_sel_hi:[0,1]
  v_cvt_pk_bf16_f32 v108, 0, v108
  v_mfma_f32_16x16x32_bf16 v[120:123], a[88:91], v[172:175], v[120:123]
  v_cvt_pk_bf16_f32 v109, 0, v109
  v_cvt_pk_bf16_f32 v110, 0, v110
  v_cvt_pk_bf16_f32 v111, 0, v111
  v_mfma_f32_16x16x32_bf16 v[116:119], a[76:79], v[176:179], v[116:119]
  v_cvt_pk_bf16_f32 v112, 0, v112
  v_cvt_pk_bf16_f32 v113, 0, v113
  buffer_load_dwordx4 v7, s[8:11], s3 offen offset:1024 nt lds
  v_mfma_f32_16x16x32_bf16 v[120:123], a[92:95], v[176:179], v[120:123]
  v_cvt_pk_bf16_f32 v114, 0, v114
  v_cvt_pk_bf16_f32 v115, 0, v115
  v_max3_f32 v75, v75, v108, v109
  v_max3_f32 v75, v75, v110, v111
  v_max3_f32 v75, v75, v112, v113
  v_max3_f32 v75, v75, v114, v115
  v_mfma_f32_16x16x32_bf16 v[124:127], a[96:99], v[164:167], 0
  v_cvt_pk_bf16_f32 v116, 0, v116
  v_cvt_pk_bf16_f32 v117, 0, v117
  v_mfma_f32_16x16x32_bf16 v[128:131], a[112:115], v[164:167], 0
  v_cvt_pk_bf16_f32 v118, 0, v118
  v_cvt_pk_bf16_f32 v119, 0, v119
  buffer_load_dwordx4 v6, s[8:11], s3 offen offset:2048 nt lds
  v_cvt_pk_bf16_f32 v120, 0, v120
  v_mfma_f32_16x16x32_bf16 v[124:127], a[100:103], v[168:171], v[124:127]
  v_cvt_pk_bf16_f32 v121, 0, v121
  v_cvt_pk_bf16_f32 v122, 0, v122
  v_cvt_pk_bf16_f32 v123, 0, v123
  v_mfma_f32_16x16x32_bf16 v[128:131], a[116:119], v[168:171], v[128:131]
  v_pk_mul_f32 v[116:117], s[66:67], v[116:117] op_sel_hi:[0,1]
  v_pk_mul_f32 v[118:119], s[66:67], v[118:119] op_sel_hi:[0,1]
  v_mfma_f32_16x16x32_bf16 v[124:127], a[104:107], v[172:175], v[124:127]
  v_pk_mul_f32 v[120:121], s[66:67], v[120:121] op_sel_hi:[0,1]
  v_pk_mul_f32 v[122:123], s[66:67], v[122:123] op_sel_hi:[0,1]
  v_cvt_pk_bf16_f32 v116, 0, v116
  v_mfma_f32_16x16x32_bf16 v[128:131], a[120:123], v[172:175], v[128:131]
  buffer_load_dwordx4 v7, s[8:11], s3 offen offset:3072 nt lds
  v_cvt_pk_bf16_f32 v117, 0, v117
  v_cvt_pk_bf16_f32 v118, 0, v118
  v_cvt_pk_bf16_f32 v119, 0, v119
  v_mfma_f32_16x16x32_bf16 v[124:127], a[108:111], v[176:179], v[124:127]
  v_cvt_pk_bf16_f32 v120, 0, v120
  v_cvt_pk_bf16_f32 v121, 0, v121
  v_mfma_f32_16x16x32_bf16 v[128:131], a[124:127], v[176:179], v[128:131]
  v_cvt_pk_bf16_f32 v122, 0, v122
  v_cvt_pk_bf16_f32 v123, 0, v123
  v_max3_f32 v75, v75, v116, v117
  v_max3_f32 v75, v75, v118, v119
  v_max3_f32 v75, v75, v120, v121
  v_max3_f32 v75, v75, v122, v123
  s_add_u32 m0, s56, 12288
  s_add_u32 s3, s55, 524288
  buffer_load_dwordx4 v6, s[8:11], s3 offen offset:0 nt lds
  v_mfma_f32_16x16x32_bf16 v[132:135], a[128:131], v[164:167], 0
  v_cvt_pk_bf16_f32 v124, 0, v124
  v_cvt_pk_bf16_f32 v125, 0, v125
  v_mfma_f32_16x16x32_bf16 v[136:139], a[144:147], v[164:167], 0
  v_cvt_pk_bf16_f32 v126, 0, v126
  v_cvt_pk_bf16_f32 v127, 0, v127
  v_cvt_pk_bf16_f32 v128, 0, v128
  v_mfma_f32_16x16x32_bf16 v[132:135], a[132:135], v[168:171], v[132:135]
  v_cvt_pk_bf16_f32 v129, 0, v129
  v_cvt_pk_bf16_f32 v130, 0, v130
  v_cvt_pk_bf16_f32 v131, 0, v131
  v_mfma_f32_16x16x32_bf16 v[136:139], a[148:151], v[168:171], v[136:139]
  v_pk_mul_f32 v[124:125], s[66:67], v[124:125] op_sel_hi:[0,1]
  buffer_load_dwordx4 v7, s[8:11], s3 offen offset:1024 nt lds
  v_pk_mul_f32 v[126:127], s[66:67], v[126:127] op_sel_hi:[0,1]
  v_mfma_f32_16x16x32_bf16 v[132:135], a[136:139], v[172:175], v[132:135]
  v_pk_mul_f32 v[128:129], s[66:67], v[128:129] op_sel_hi:[0,1]
  v_pk_mul_f32 v[130:131], s[66:67], v[130:131] op_sel_hi:[0,1]
  v_cvt_pk_bf16_f32 v124, 0, v124
  v_mfma_f32_16x16x32_bf16 v[136:139], a[152:155], v[172:175], v[136:139]
  v_cvt_pk_bf16_f32 v125, 0, v125
  v_cvt_pk_bf16_f32 v126, 0, v126
  v_cvt_pk_bf16_f32 v127, 0, v127
  v_mfma_f32_16x16x32_bf16 v[132:135], a[140:143], v[176:179], v[132:135]
  v_cvt_pk_bf16_f32 v128, 0, v128
  v_cvt_pk_bf16_f32 v129, 0, v129
  v_mfma_f32_16x16x32_bf16 v[136:139], a[156:159], v[176:179], v[136:139]
  buffer_load_dwordx4 v6, s[8:11], s3 offen offset:2048 nt lds
  v_cvt_pk_bf16_f32 v130, 0, v130
  v_cvt_pk_bf16_f32 v131, 0, v131
  v_max3_f32 v75, v75, v124, v125
  v_max3_f32 v75, v75, v126, v127
  v_max3_f32 v75, v75, v128, v129
  v_max3_f32 v75, v75, v130, v131
  v_mfma_f32_16x16x32_bf16 v[140:143], a[160:163], v[164:167], 0
  v_cvt_pk_bf16_f32 v132, 0, v132
  v_cvt_pk_bf16_f32 v133, 0, v133
  v_cvt_pk_bf16_f32 v134, 0, v134
  v_cvt_pk_bf16_f32 v135, 0, v135
  v_cvt_pk_bf16_f32 v136, 0, v136
  v_mfma_f32_16x16x32_bf16 v[140:143], a[164:167], v[168:171], v[140:143]
  buffer_load_dwordx4 v7, s[8:11], s3 offen offset:3072 nt lds
  v_cvt_pk_bf16_f32 v137, 0, v137
  v_cvt_pk_bf16_f32 v138, 0, v138
  v_cvt_pk_bf16_f32 v139, 0, v139
  v_pk_mul_f32 v[132:133], s[66:67], v[132:133] op_sel_hi:[0,1]
  v_pk_mul_f32 v[134:135], s[66:67], v[134:135] op_sel_hi:[0,1]
  v_mfma_f32_16x16x32_bf16 v[140:143], a[168:171], v[172:175], v[140:143]
  v_pk_mul_f32 v[136:137], s[66:67], v[136:137] op_sel_hi:[0,1]
  v_pk_mul_f32 v[138:139], s[66:67], v[138:139] op_sel_hi:[0,1]
  v_cvt_pk_bf16_f32 v132, 0, v132
  v_cvt_pk_bf16_f32 v133, 0, v133
  v_cvt_pk_bf16_f32 v134, 0, v134
  v_cvt_pk_bf16_f32 v135, 0, v135
  v_mfma_f32_16x16x32_bf16 v[140:143], a[172:175], v[176:179], v[140:143]
  v_cvt_pk_bf16_f32 v136, 0, v136
  v_cvt_pk_bf16_f32 v137, 0, v137
  v_cvt_pk_bf16_f32 v138, 0, v138
  v_cvt_pk_bf16_f32 v139, 0, v139
  v_max3_f32 v75, v75, v132, v133
  v_max3_f32 v75, v75, v134, v135
  v_max3_f32 v75, v75, v136, v137
  v_max3_f32 v75, v75, v138, v139
  v_cvt_pk_bf16_f32 v140, 0, v140
  v_cvt_pk_bf16_f32 v141, 0, v141
  v_cvt_pk_bf16_f32 v142, 0, v142
  v_cvt_pk_bf16_f32 v143, 0, v143
  v_pk_mul_f32 v[140:141], s[66:67], v[140:141] op_sel_hi:[0,1]
  v_pk_mul_f32 v[142:143], s[66:67], v[142:143] op_sel_hi:[0,1]
  v_cvt_pk_bf16_f32 v140, 0, v140
  v_cvt_pk_bf16_f32 v141, 0, v141
  v_cvt_pk_bf16_f32 v142, 0, v142
  v_cvt_pk_bf16_f32 v143, 0, v143
  v_max3_f32 v75, v75, v140, v141
  v_max3_f32 v75, v75, v142, v143
  s_waitcnt vmcnt(24) lgkmcnt(0)
  ds_read_b128 a[176:179], v10 offset:20480
  ds_read_b128 a[180:183], v11 offset:20480
  ds_read_b128 a[184:187], v12 offset:20480
  ds_read_b128 a[188:191], v13 offset:20480
  v_pk_add_f32 v[196:197], v[54:55], v[180:181] neg_lo:[0,1] neg_hi:[0,1]
  v_pk_add_f32 v[198:199], v[56:57], v[182:183] neg_lo:[0,1] neg_hi:[0,1]
  v_pk_add_f32 v[200:201], v[58:59], v[184:185] neg_lo:[0,1] neg_hi:[0,1]
  v_pk_add_f32 v[202:203], v[60:61], v[186:187] neg_lo:[0,1] neg_hi:[0,1]
  v_pk_add_f32 v[204:205], v[62:63], v[188:189] neg_lo:[0,1] neg_hi:[0,1]
  v_pk_add_f32 v[206:207], v[64:65], v[190:191] neg_lo:[0,1] neg_hi:[0,1]
  v_pk_add_f32 v[208:209], v[66:67], v[192:193] neg_lo:[0,1] neg_hi:[0,1]
  v_cvt_pk_bf16_f32 v196, 0, v196
  v_cvt_pk_bf16_f32 v197, 0, v197
  v_cvt_pk_bf16_f32 v198, 0, v198
  v_cvt_pk_bf16_f32 v199, 0, v199
  v_cvt_pk_bf16_f32 v200, 0, v200
  v_cvt_pk_bf16_f32 v201, 0, v201
  v_cvt_pk_bf16_f32 v202, 0, v202
  v_cvt_pk_bf16_f32 v203, 0, v203
  v_cvt_pk_bf16_f32 v204, 0, v204
  v_cvt_pk_bf16_f32 v205, 0, v205
  v_cvt_pk_bf16_f32 v206, 0, v206
  v_cvt_pk_bf16_f32 v207, 0, v207
  v_cvt_pk_bf16_f32 v208, 0, v208
  v_cvt_pk_bf16_f32 v209, 0, v209
  v_pk_mul_f32 v[210:211], v[196:197], v[196:197]
  v_pk_mul_f32 v[212:213], v[198:199], v[198:199]
  v_pk_mul_f32 v[214:215], v[200:201], v[200:201]
  v_pk_mul_f32 v[216:217], v[202:203], v[202:203]
  v_pk_mul_f32 v[218:219], v[204:205], v[204:205]
  v_pk_mul_f32 v[220:221], v[206:207], v[206:207]
  v_pk_mul_f32 v[222:223], v[208:209], v[208:209]
  v_pk_fma_f32 v[210:211], v[210:211], s[100:101], v[36:37] op_sel_hi:[1,0,1]
  v_pk_fma_f32 v[212:213], v[212:213], s[100:101], v[36:37] op_sel_hi:[1,0,1]
  v_pk_fma_f32 v[214:215], v[214:215], s[100:101], v[36:37] op_sel_hi:[1,0,1]
  v_pk_fma_f32 v[216:217], v[216:217], s[100:101], v[36:37] op_sel_hi:[1,0,1]
  v_pk_fma_f32 v[218:219], v[218:219], s[100:101], v[36:37] op_sel_hi:[1,0,1]
  v_pk_fma_f32 v[220:221], v[220:221], s[100:101], v[36:37] op_sel_hi:[1,0,1]
  v_pk_fma_f32 v[222:223], v[222:223], s[100:101], v[36:37] op_sel_hi:[1,0,1]
  v_pk_mul_f32 v[210:211], v[210:211], v[196:197]
  v_pk_mul_f32 v[212:213], v[212:213], v[198:199]
  v_pk_mul_f32 v[214:215], v[214:215], v[200:201]
  v_pk_mul_f32 v[216:217], v[216:217], v[202:203]
  v_pk_mul_f32 v[218:219], v[218:219], v[204:205]
  v_pk_mul_f32 v[220:221], v[220:221], v[206:207]
  v_pk_mul_f32 v[222:223], v[222:223], v[208:209]
  v_exp_f32 v210, v210
  v_exp_f32 v211, v211
  v_exp_f32 v212, v212
  v_exp_f32 v213, v213
  v_exp_f32 v214, v214
  v_exp_f32 v215, v215
  v_exp_f32 v216, v216
  v_exp_f32 v217, v217
  v_exp_f32 v218, v218
  v_exp_f32 v219, v219
  v_exp_f32 v220, v220
  v_exp_f32 v221, v221
  v_exp_f32 v222, v222
  v_exp_f32 v223, v223
  v_pk_add_f32 v[210:211], v[210:211], v[38:39]
  v_pk_add_f32 v[212:213], v[212:213], v[38:39]
  v_pk_add_f32 v[214:215], v[214:215], v[38:39]
  v_pk_add_f32 v[216:217], v[216:217], v[38:39]
  v_pk_add_f32 v[218:219], v[218:219], v[38:39]
  v_pk_add_f32 v[220:221], v[220:221], v[38:39]
  v_pk_add_f32 v[222:223], v[222:223], v[38:39]
  v_rcp_f32 v210, v210
  v_rcp_f32 v211, v211
  v_rcp_f32 v212, v212
  v_rcp_f32 v213, v213
  v_rcp_f32 v214, v214
  v_rcp_f32 v215, v215
  v_rcp_f32 v216, v216
  v_rcp_f32 v217, v217
  v_rcp_f32 v218, v218
  v_rcp_f32 v219, v219
  v_rcp_f32 v220, v220
  v_rcp_f32 v221, v221
  v_rcp_f32 v222, v222
  v_rcp_f32 v223, v223
  v_pk_mul_f32 v[210:211], v[210:211], v[196:197]
  v_pk_mul_f32 v[212:213], v[212:213], v[198:199]
  v_pk_mul_f32 v[214:215], v[214:215], v[200:201]
  v_pk_mul_f32 v[216:217], v[216:217], v[202:203]
  v_pk_mul_f32 v[218:219], v[218:219], v[204:205]
  v_pk_mul_f32 v[220:221], v[220:221], v[206:207]
  v_pk_mul_f32 v[222:223], v[222:223], v[208:209]
  v_cvt_pk_bf16_f32 v196, v210, v211
  v_cvt_pk_bf16_f32 v197, v212, v213
  v_cvt_pk_bf16_f32 v198, v214, v215
  v_cvt_pk_bf16_f32 v199, v216, v217
  v_cvt_pk_bf16_f32 v200, v218, v219
  v_cvt_pk_bf16_f32 v201, v220, v221
  v_cvt_pk_bf16_f32 v202, v222, v223
  v_dot2c_f32_bf16 v94, v196, v68
  v_dot2c_f32_bf16 v94, v197, v69
  v_dot2c_f32_bf16 v94, v198, v70
  v_dot2c_f32_bf16 v94, v199, v71
  v_dot2c_f32_bf16 v94, v200, v72
  v_dot2c_f32_bf16 v94, v201, v73
  v_dot2c_f32_bf16 v94, v202, v74
  s_waitcnt vmcnt(20) lgkmcnt(0)
  ds_read_b128 a[192:195], v10 offset:24576
  ds_read_b128 a[196:199], v11 offset:24576
  ds_read_b128 a[200:203], v12 offset:24576
  ds_read_b128 a[204:207], v13 offset:24576
  v_mfma_f32_16x16x32_bf16 v[144:147], a[176:179], v[164:167], 0
  s_add_u32 s96, s97, 196608
  v_pk_mul_f32 v[180:181], s[96:97], v[40:41] op_sel_hi:[0,1]
  v_pk_mul_f32 v[182:183], s[96:97], v[42:43] op_sel_hi:[0,1]
  v_pk_mul_f32 v[184:185], s[96:97], v[44:45] op_sel_hi:[0,1]
  v_pk_mul_f32 v[186:187], s[96:97], v[46:47] op_sel_hi:[0,1]
  v_pk_mul_f32 v[188:189], s[96:97], v[48:49] op_sel_hi:[0,1]
  v_pk_mul_f32 v[190:191], s[96:97], v[50:51] op_sel_hi:[0,1]
  v_pk_mul_f32 v[192:193], s[96:97], v[52:53] op_sel_hi:[0,1]
  v_cvt_pk_bf16_f32 v180, 0, v180
  v_cvt_pk_bf16_f32 v181, 0, v181
  v_cvt_pk_bf16_f32 v182, 0, v182
  v_cvt_pk_bf16_f32 v183, 0, v183
  v_cvt_pk_bf16_f32 v184, 0, v184
  v_cvt_pk_bf16_f32 v185, 0, v185
  v_cvt_pk_bf16_f32 v186, 0, v186
  v_cvt_pk_bf16_f32 v187, 0, v187
  v_cvt_pk_bf16_f32 v188, 0, v188
  v_cvt_pk_bf16_f32 v189, 0, v189
  v_cvt_pk_bf16_f32 v190, 0, v190
  v_cvt_pk_bf16_f32 v191, 0, v191
  v_cvt_pk_bf16_f32 v192, 0, v192
  v_mfma_f32_16x16x32_bf16 v[144:147], a[180:183], v[168:171], v[144:147]
  v_cvt_pk_bf16_f32 v193, 0, v193
  v_pk_add_f32 v[196:197], v[54:55], v[180:181]
  v_pk_add_f32 v[198:199], v[56:57], v[182:183]
  v_pk_add_f32 v[200:201], v[58:59], v[184:185]
  v_pk_add_f32 v[202:203], v[60:61], v[186:187]
  v_pk_add_f32 v[204:205], v[62:63], v[188:189]
  v_pk_add_f32 v[206:207], v[64:65], v[190:191]
  v_pk_add_f32 v[208:209], v[66:67], v[192:193]
  v_cvt_pk_bf16_f32 v196, 0, v196
  v_cvt_pk_bf16_f32 v197, 0, v197
  v_cvt_pk_bf16_f32 v198, 0, v198
  v_cvt_pk_bf16_f32 v199, 0, v199
  v_cvt_pk_bf16_f32 v200, 0, v200
  v_cvt_pk_bf16_f32 v201, 0, v201
  v_cvt_pk_bf16_f32 v202, 0, v202
  v_cvt_pk_bf16_f32 v203, 0, v203
  v_cvt_pk_bf16_f32 v204, 0, v204
  v_cvt_pk_bf16_f32 v205, 0, v205
  v_cvt_pk_bf16_f32 v206, 0, v206
  v_cvt_pk_bf16_f32 v207, 0, v207
  v_cvt_pk_bf16_f32 v208, 0, v208
  v_mfma_f32_16x16x32_bf16 v[144:147], a[184:187], v[172:175], v[144:147]
  v_cvt_pk_bf16_f32 v209, 0, v209
  v_pk_mul_f32 v[210:211], v[196:197], v[196:197]
  v_pk_mul_f32 v[212:213], v[198:199], v[198:199]
  v_pk_mul_f32 v[214:215], v[200:201], v[200:201]
  v_pk_mul_f32 v[216:217], v[202:203], v[202:203]
  v_pk_mul_f32 v[218:219], v[204:205], v[204:205]
  v_pk_mul_f32 v[220:221], v[206:207], v[206:207]
  v_pk_mul_f32 v[222:223], v[208:209], v[208:209]
  v_pk_fma_f32 v[210:211], v[210:211], s[100:101], v[36:37] op_sel_hi:[1,0,1]
  v_pk_fma_f32 v[212:213], v[212:213], s[100:101], v[36:37] op_sel_hi:[1,0,1]
  v_pk_fma_f32 v[214:215], v[214:215], s[100:101], v[36:37] op_sel_hi:[1,0,1]
  v_pk_fma_f32 v[216:217], v[216:217], s[100:101], v[36:37] op_sel_hi:[1,0,1]
  v_pk_fma_f32 v[218:219], v[218:219], s[100:101], v[36:37] op_sel_hi:[1,0,1]
  v_pk_fma_f32 v[220:221], v[220:221], s[100:101], v[36:37] op_sel_hi:[1,0,1]
  v_pk_fma_f32 v[222:223], v[222:223], s[100:101], v[36:37] op_sel_hi:[1,0,1]
  v_pk_mul_f32 v[210:211], v[210:211], v[196:197]
  v_pk_mul_f32 v[212:213], v[212:213], v[198:199]
  v_pk_mul_f32 v[214:215], v[214:215], v[200:201]
  v_pk_mul_f32 v[216:217], v[216:217], v[202:203]
  v_pk_mul_f32 v[218:219], v[218:219], v[204:205]
  v_pk_mul_f32 v[220:221], v[220:221], v[206:207]
  v_mfma_f32_16x16x32_bf16 v[144:147], a[188:191], v[176:179], v[144:147]
  v_pk_mul_f32 v[222:223], v[222:223], v[208:209]
  v_exp_f32 v210, v210
  v_exp_f32 v211, v211
  v_exp_f32 v212, v212
  v_exp_f32 v213, v213
  v_exp_f32 v214, v214
  v_exp_f32 v215, v215
  v_exp_f32 v216, v216
  v_exp_f32 v217, v217
  v_exp_f32 v218, v218
  v_exp_f32 v219, v219
  v_exp_f32 v220, v220
  v_exp_f32 v221, v221
  v_exp_f32 v222, v222
  v_exp_f32 v223, v223
  v_pk_add_f32 v[210:211], v[210:211], v[38:39]
  v_pk_add_f32 v[212:213], v[212:213], v[38:39]
  v_pk_add_f32 v[214:215], v[214:215], v[38:39]
  v_pk_add_f32 v[216:217], v[216:217], v[38:39]
  v_pk_add_f32 v[218:219], v[218:219], v[38:39]
  v_pk_add_f32 v[220:221], v[220:221], v[38:39]
  v_pk_add_f32 v[222:223], v[222:223], v[38:39]
  v_rcp_f32 v210, v210
  v_rcp_f32 v211, v211
  v_rcp_f32 v212, v212
  v_rcp_f32 v213, v213
  v_rcp_f32 v214, v214
  v_rcp_f32 v215, v215
  v_rcp_f32 v216, v216
  v_rcp_f32 v217, v217
  v_rcp_f32 v218, v218
  v_rcp_f32 v219, v219
  v_rcp_f32 v220, v220
  v_rcp_f32 v221, v221
  v_rcp_f32 v222, v222
  v_rcp_f32 v223, v223
  v_pk_mul_f32 v[210:211], v[210:211], v[196:197]
  v_pk_mul_f32 v[212:213], v[212:213], v[198:199]
  v_pk_mul_f32 v[214:215], v[214:215], v[200:201]
  v_pk_mul_f32 v[216:217], v[216:217], v[202:203]
  v_pk_mul_f32 v[218:219], v[218:219], v[204:205]
  v_pk_mul_f32 v[220:221], v[220:221], v[206:207]
  v_pk_mul_f32 v[222:223], v[222:223], v[208:209]
  v_cvt_pk_bf16_f32 v196, v210, v211
  v_cvt_pk_bf16_f32 v197, v212, v213
  v_cvt_pk_bf16_f32 v198, v214, v215
  v_cvt_pk_bf16_f32 v199, v216, v217
  v_cvt_pk_bf16_f32 v200, v218, v219
  v_cvt_pk_bf16_f32 v201, v220, v221
  v_cvt_pk_bf16_f32 v202, v222, v223
  v_dot2c_f32_bf16 v87, v196, v68
  v_dot2c_f32_bf16 v87, v197, v69
  v_dot2c_f32_bf16 v87, v198, v70
  v_dot2c_f32_bf16 v87, v199, v71
  v_dot2c_f32_bf16 v87, v200, v72
  v_dot2c_f32_bf16 v87, v201, v73
  v_dot2c_f32_bf16 v87, v202, v74
  v_cvt_pk_bf16_f32 v144, 0, v144
  v_cvt_pk_bf16_f32 v145, 0, v145
  v_cvt_pk_bf16_f32 v146, 0, v146
  v_cvt_pk_bf16_f32 v147, 0, v147
  v_pk_mul_f32 v[144:145], s[66:67], v[144:145] op_sel_hi:[0,1]
  v_pk_mul_f32 v[146:147], s[66:67], v[146:147] op_sel_hi:[0,1]
  v_cvt_pk_bf16_f32 v144, 0, v144
  v_cvt_pk_bf16_f32 v145, 0, v145
  v_cvt_pk_bf16_f32 v146, 0, v146
  v_cvt_pk_bf16_f32 v147, 0, v147
  v_max3_f32 v75, v75, v144, v145
  v_max3_f32 v75, v75, v146, v147
  s_waitcnt vmcnt(16) lgkmcnt(0)
  ds_read_b128 a[208:211], v10 offset:28672
  ds_read_b128 a[212:215], v11 offset:28672
  ds_read_b128 a[216:219], v12 offset:28672
  ds_read_b128 a[220:223], v13 offset:28672
  v_mfma_f32_16x16x32_bf16 v[148:151], a[192:195], v[164:167], 0
  v_pk_add_f32 v[196:197], v[54:55], v[180:181] neg_lo:[0,1] neg_hi:[0,1]
  v_pk_add_f32 v[198:199], v[56:57], v[182:183] neg_lo:[0,1] neg_hi:[0,1]
  v_pk_add_f32 v[200:201], v[58:59], v[184:185] neg_lo:[0,1] neg_hi:[0,1]
  v_pk_add_f32 v[202:203], v[60:61], v[186:187] neg_lo:[0,1] neg_hi:[0,1]
  v_pk_add_f32 v[204:205], v[62:63], v[188:189] neg_lo:[0,1] neg_hi:[0,1]
  v_pk_add_f32 v[206:207], v[64:65], v[190:191] neg_lo:[0,1] neg_hi:[0,1]
  v_pk_add_f32 v[208:209], v[66:67], v[192:193] neg_lo:[0,1] neg_hi:[0,1]
  v_cvt_pk_bf16_f32 v196, 0, v196
  v_cvt_pk_bf16_f32 v197, 0, v197
  v_cvt_pk_bf16_f32 v198, 0, v198
  v_cvt_pk_bf16_f32 v199, 0, v199
  v_cvt_pk_bf16_f32 v200, 0, v200
  v_cvt_pk_bf16_f32 v201, 0, v201
  v_cvt_pk_bf16_f32 v202, 0, v202
  v_cvt_pk_bf16_f32 v203, 0, v203
  v_cvt_pk_bf16_f32 v204, 0, v204
  v_cvt_pk_bf16_f32 v205, 0, v205
  v_mfma_f32_16x16x32_bf16 v[148:151], a[196:199], v[168:171], v[148:151]
  v_cvt_pk_bf16_f32 v206, 0, v206
  v_cvt_pk_bf16_f32 v207, 0, v207
  v_cvt_pk_bf16_f32 v208, 0, v208
  v_cvt_pk_bf16_f32 v209, 0, v209
  v_pk_mul_f32 v[210:211], v[196:197], v[196:197]
  v_pk_mul_f32 v[212:213], v[198:199], v[198:199]
  v_pk_mul_f32 v[214:215], v[200:201], v[200:201]
  v_pk_mul_f32 v[216:217], v[202:203], v[202:203]
  v_pk_mul_f32 v[218:219], v[204:205], v[204:205]
  v_pk_mul_f32 v[220:221], v[206:207], v[206:207]
  v_pk_mul_f32 v[222:223], v[208:209], v[208:209]
  v_pk_fma_f32 v[210:211], v[210:211], s[100:101], v[36:37] op_sel_hi:[1,0,1]
  v_pk_fma_f32 v[212:213], v[212:213], s[100:101], v[36:37] op_sel_hi:[1,0,1]
  v_pk_fma_f32 v[214:215], v[214:215], s[100:101], v[36:37] op_sel_hi:[1,0,1]
  v_pk_fma_f32 v[216:217], v[216:217], s[100:101], v[36:37] op_sel_hi:[1,0,1]
  v_pk_fma_f32 v[218:219], v[218:219], s[100:101], v[36:37] op_sel_hi:[1,0,1]
  v_pk_fma_f32 v[220:221], v[220:221], s[100:101], v[36:37] op_sel_hi:[1,0,1]
  v_mfma_f32_16x16x32_bf16 v[148:151], a[200:203], v[172:175], v[148:151]
  v_pk_fma_f32 v[222:223], v[222:223], s[100:101], v[36:37] op_sel_hi:[1,0,1]
  v_pk_mul_f32 v[210:211], v[210:211], v[196:197]
  v_pk_mul_f32 v[212:213], v[212:213], v[198:199]
  v_pk_mul_f32 v[214:215], v[214:215], v[200:201]
  v_pk_mul_f32 v[216:217], v[216:217], v[202:203]
  v_pk_mul_f32 v[218:219], v[218:219], v[204:205]
  v_pk_mul_f32 v[220:221], v[220:221], v[206:207]
  v_pk_mul_f32 v[222:223], v[222:223], v[208:209]
  v_exp_f32 v210, v210
  v_exp_f32 v211, v211
  v_exp_f32 v212, v212
  v_exp_f32 v213, v213
  v_exp_f32 v214, v214
  v_exp_f32 v215, v215
  v_exp_f32 v216, v216
  v_exp_f32 v217, v217
  v_exp_f32 v218, v218
  v_mfma_f32_16x16x32_bf16 v[148:151], a[204:207], v[176:179], v[148:151]
  v_exp_f32 v219, v219
  v_exp_f32 v220, v220
  v_exp_f32 v221, v221
  v_exp_f32 v222, v222
  v_exp_f32 v223, v223
  v_pk_add_f32 v[210:211], v[210:211], v[38:39]
  v_pk_add_f32 v[212:213], v[212:213], v[38:39]
  v_pk_add_f32 v[214:215], v[214:215], v[38:39]
  v_pk_add_f32 v[216:217], v[216:217], v[38:39]
  v_pk_add_f32 v[218:219], v[218:219], v[38:39]
  v_pk_add_f32 v[220:221], v[220:221], v[38:39]
  v_pk_add_f32 v[222:223], v[222:223], v[38:39]
  v_rcp_f32 v210, v210
  v_rcp_f32 v211, v211
  v_rcp_f32 v212, v212
  v_rcp_f32 v213, v213
  v_rcp_f32 v214, v214
  v_rcp_f32 v215, v215
  v_rcp_f32 v216, v216
  v_rcp_f32 v217, v217
  v_rcp_f32 v218, v218
  v_rcp_f32 v219, v219
  v_rcp_f32 v220, v220
  v_rcp_f32 v221, v221
  v_rcp_f32 v222, v222
  v_rcp_f32 v223, v223
  v_pk_mul_f32 v[210:211], v[210:211], v[196:197]
  v_pk_mul_f32 v[212:213], v[212:213], v[198:199]
  v_pk_mul_f32 v[214:215], v[214:215], v[200:201]
  v_pk_mul_f32 v[216:217], v[216:217], v[202:203]
  v_pk_mul_f32 v[218:219], v[218:219], v[204:205]
  v_pk_mul_f32 v[220:221], v[220:221], v[206:207]
  v_pk_mul_f32 v[222:223], v[222:223], v[208:209]
  v_cvt_pk_bf16_f32 v196, v210, v211
  v_cvt_pk_bf16_f32 v197, v212, v213
  v_cvt_pk_bf16_f32 v198, v214, v215
  v_cvt_pk_bf16_f32 v199, v216, v217
  v_cvt_pk_bf16_f32 v200, v218, v219
  v_cvt_pk_bf16_f32 v201, v220, v221
  v_cvt_pk_bf16_f32 v202, v222, v223
  v_dot2c_f32_bf16 v95, v196, v68
  v_dot2c_f32_bf16 v95, v197, v69
  v_dot2c_f32_bf16 v95, v198, v70
  v_dot2c_f32_bf16 v95, v199, v71
  v_dot2c_f32_bf16 v95, v200, v72
  v_dot2c_f32_bf16 v95, v201, v73
  v_dot2c_f32_bf16 v95, v202, v74
  v_cvt_pk_bf16_f32 v148, 0, v148
  v_cvt_pk_bf16_f32 v149, 0, v149
  v_cvt_pk_bf16_f32 v150, 0, v150
  v_cvt_pk_bf16_f32 v151, 0, v151
  v_pk_mul_f32 v[148:149], s[66:67], v[148:149] op_sel_hi:[0,1]
  v_pk_mul_f32 v[150:151], s[66:67], v[150:151] op_sel_hi:[0,1]
  v_cvt_pk_bf16_f32 v148, 0, v148
  v_cvt_pk_bf16_f32 v149, 0, v149
  v_cvt_pk_bf16_f32 v150, 0, v150
  v_cvt_pk_bf16_f32 v151, 0, v151
  v_max3_f32 v75, v75, v148, v149
  v_max3_f32 v75, v75, v150, v151
  s_waitcnt vmcnt(12) lgkmcnt(0)
  ds_read_b128 a[224:227], v10 offset:0
  ds_read_b128 a[228:231], v11 offset:0
  ds_read_b128 a[232:235], v12 offset:0
  ds_read_b128 a[236:239], v13 offset:0
  s_add_u32 m0, s56, 16384
  s_add_u32 s3, s55, 1048576
  buffer_load_dwordx4 v6, s[8:11], s3 offen offset:0 nt lds
  buffer_load_dwordx4 v7, s[8:11], s3 offen offset:1024 nt lds
  buffer_load_dwordx4 v6, s[8:11], s3 offen offset:2048 nt lds
  buffer_load_dwordx4 v7, s[8:11], s3 offen offset:3072 nt lds
  v_mfma_f32_16x16x32_bf16 v[152:155], a[208:211], v[164:167], 0
  v_mfma_f32_16x16x32_bf16 v[152:155], a[212:215], v[168:171], v[152:155]
  v_mfma_f32_16x16x32_bf16 v[152:155], a[216:219], v[172:175], v[152:155]
  v_mfma_f32_16x16x32_bf16 v[152:155], a[220:223], v[176:179], v[152:155]
  s_nop 7
  v_cvt_pk_bf16_f32 v152, 0, v152
  v_cvt_pk_bf16_f32 v153, 0, v153
  v_cvt_pk_bf16_f32 v154, 0, v154
  v_cvt_pk_bf16_f32 v155, 0, v155
  v_pk_mul_f32 v[152:153], s[66:67], v[152:153] op_sel_hi:[0,1]
  v_pk_mul_f32 v[154:155], s[66:67], v[154:155] op_sel_hi:[0,1]
  v_cvt_pk_bf16_f32 v152, 0, v152
  v_cvt_pk_bf16_f32 v153, 0, v153
  v_cvt_pk_bf16_f32 v154, 0, v154
  v_cvt_pk_bf16_f32 v155, 0, v155
  v_max3_f32 v75, v75, v152, v153
  v_max3_f32 v75, v75, v154, v155
  s_waitcnt vmcnt(12) lgkmcnt(0)
  ds_read_b128 a[240:243], v10 offset:4096
  ds_read_b128 a[244:247], v11 offset:4096
  ds_read_b128 a[248:251], v12 offset:4096
  ds_read_b128 a[252:255], v13 offset:4096
  v_mfma_f32_16x16x32_bf16 v[156:159], a[224:227], v[164:167], 0
  v_mfma_f32_16x16x32_bf16 v[156:159], a[228:231], v[168:171], v[156:159]
  v_mfma_f32_16x16x32_bf16 v[156:159], a[232:235], v[172:175], v[156:159]
  v_mfma_f32_16x16x32_bf16 v[156:159], a[236:239], v[176:179], v[156:159]
  s_nop 7
  v_cvt_pk_bf16_f32 v156, 0, v156
  v_cvt_pk_bf16_f32 v157, 0, v157
  v_cvt_pk_bf16_f32 v158, 0, v158
  v_cvt_pk_bf16_f32 v159, 0, v159
  v_pk_mul_f32 v[156:157], s[66:67], v[156:157] op_sel_hi:[0,1]
  v_pk_mul_f32 v[158:159], s[66:67], v[158:159] op_sel_hi:[0,1]
  v_cvt_pk_bf16_f32 v156, 0, v156
  v_cvt_pk_bf16_f32 v157, 0, v157
  v_cvt_pk_bf16_f32 v158, 0, v158
  v_cvt_pk_bf16_f32 v159, 0, v159
  v_max3_f32 v75, v75, v156, v157
  v_max3_f32 v75, v75, v158, v159
  s_waitcnt lgkmcnt(0)
  s_add_u32 m0, s56, 20480
  s_add_u32 s3, s55, 1572864
  buffer_load_dwordx4 v6, s[8:11], s3 offen offset:0 nt lds
  v_mfma_f32_16x16x32_bf16 v[160:163], a[240:243], v[164:167], 0
  v_mfma_f32_16x16x32_bf16 v[160:163], a[244:247], v[168:171], v[160:163]
  v_mfma_f32_16x16x32_bf16 v[160:163], a[248:251], v[172:175], v[160:163]
  v_mfma_f32_16x16x32_bf16 v[160:163], a[252:255], v[176:179], v[160:163]
  s_nop 7
  v_cvt_pk_bf16_f32 v160, 0, v160
  v_cvt_pk_bf16_f32 v161, 0, v161
  v_cvt_pk_bf16_f32 v162, 0, v162
  v_cvt_pk_bf16_f32 v163, 0, v163
  buffer_load_dwordx4 v7, s[8:11], s3 offen offset:1024 nt lds
  v_pk_mul_f32 v[160:161], s[66:67], v[160:161] op_sel_hi:[0,1]
  v_pk_mul_f32 v[162:163], s[66:67], v[162:163] op_sel_hi:[0,1]
  v_cvt_pk_bf16_f32 v160, 0, v160
  v_cvt_pk_bf16_f32 v161, 0, v161
  v_cvt_pk_bf16_f32 v162, 0, v162
  v_cvt_pk_bf16_f32 v163, 0, v163
  v_max3_f32 v75, v75, v160, v161
  v_max3_f32 v75, v75, v162, v163
  buffer_load_dwordx4 v6, s[8:11], s3 offen offset:2048 nt lds
  v_mov_b32 v196, v75
  s_nop 1
  v_permlane16_swap_b32 v75, v196
  v_max_f32 v75, v75, v196
  v_mov_b32 v196, v75
  s_nop 1
  v_permlane32_swap_b32 v75, v196
  v_max_f32 v75, v75, v196
  v_lshlrev_b32 v197, 2, v32
  s_lshl_b32 s59, s52, 6
  s_add_u32 s59, s59, 135168
  buffer_load_dwordx4 v7, s[8:11], s3 offen offset:3072 nt lds
  v_add_u32 v198, s59, v197
  ds_write_b32 v198, v75
  v_add_u32 v197, 135168, v197
  s_waitcnt lgkmcnt(0)
  s_barrier
  ds_read_b32 v200, v197 offset:0
  ds_read_b32 v201, v197 offset:64
  ds_read_b32 v202, v197 offset:128
  s_add_u32 m0, s56, 24576
  s_add_u32 s3, s55, 2097152
  buffer_load_dwordx4 v6, s[8:11], s3 offen offset:0 nt lds
  ds_read_b32 v203, v197 offset:192
  s_mov_b32 s66, 0x3fb8aa3b
  s_waitcnt lgkmcnt(0)
  v_max3_f32 v75, v200, v201, v202
  v_max_f32 v75, v75, v203
  v_mul_f32 v196, 0xbfb8aa3b, v75
  v_pk_fma_f32 v[200:201], v[100:101], s[66:67], v[196:197] op_sel_hi:[1,0,0]
  v_pk_fma_f32 v[202:203], v[102:103], s[66:67], v[196:197] op_sel_hi:[1,0,0]
  v_pk_fma_f32 v[204:205], v[104:105], s[66:67], v[196:197] op_sel_hi:[1,0,0]
  buffer_load_dwordx4 v7, s[8:11], s3 offen offset:1024 nt lds
  v_pk_fma_f32 v[206:207], v[106:107], s[66:67], v[196:197] op_sel_hi:[1,0,0]
  v_exp_f32 v200, v200
  v_exp_f32 v201, v201
  v_exp_f32 v202, v202
  v_exp_f32 v203, v203
  v_exp_f32 v204, v204
  v_exp_f32 v205, v205
  v_exp_f32 v206, v206
  buffer_load_dwordx4 v6, s[8:11], s3 offen offset:2048 nt lds
  v_exp_f32 v207, v207
  v_cvt_pk_bf16_f32 v100, v200, v201
  v_cvt_pk_bf16_f32 v101, v202, v203
  v_cvt_pk_bf16_f32 v102, v204, v205
  v_cvt_pk_bf16_f32 v103, v206, v207
  v_pk_add_f32 v[200:201], v[200:201], v[202:203]
  v_pk_add_f32 v[204:205], v[204:205], v[206:207]
  v_pk_add_f32 v[198:199], v[200:201], v[204:205]
  buffer_load_dwordx4 v7, s[8:11], s3 offen offset:3072 nt lds
  v_pk_fma_f32 v[200:201], v[108:109], s[66:67], v[196:197] op_sel_hi:[1,0,0]
  v_pk_fma_f32 v[202:203], v[110:111], s[66:67], v[196:197] op_sel_hi:[1,0,0]
  v_pk_fma_f32 v[204:205], v[112:113], s[66:67], v[196:197] op_sel_hi:[1,0,0]
  v_pk_fma_f32 v[206:207], v[114:115], s[66:67], v[196:197] op_sel_hi:[1,0,0]
  v_exp_f32 v200, v200
  v_exp_f32 v201, v201
  v_exp_f32 v202, v202
  v_exp_f32 v203, v203
  v_exp_f32 v204, v204
  s_add_u32 m0, s56, 28672
  s_add_u32 s3, s55, 2621440
  buffer_load_dwordx4 v6, s[8:11], s3 offen offset:0 nt lds
  v_exp_f32 v205, v205
  v_exp_f32 v206, v206
  v_exp_f32 v207, v207
  v_cvt_pk_bf16_f32 v104, v200, v201
  v_cvt_pk_bf16_f32 v105, v202, v203
  v_cvt_pk_bf16_f32 v106, v204, v205
  v_cvt_pk_bf16_f32 v107, v206, v207
  v_pk_add_f32 v[200:201], v[200:201], v[202:203]
  buffer_load_dwordx4 v7, s[8:11], s3 offen offset:1024 nt lds
  v_pk_add_f32 v[204:205], v[204:205], v[206:207]
  v_pk_add_f32 v[200:201], v[200:201], v[204:205]
  v_pk_add_f32 v[198:199], v[198:199], v[200:201]
  v_pk_fma_f32 v[200:201], v[116:117], s[66:67], v[196:197] op_sel_hi:[1,0,0]
  v_pk_fma_f32 v[202:203], v[118:119], s[66:67], v[196:197] op_sel_hi:[1,0,0]
  v_pk_fma_f32 v[204:205], v[120:121], s[66:67], v[196:197] op_sel_hi:[1,0,0]
  v_pk_fma_f32 v[206:207], v[122:123], s[66:67], v[196:197] op_sel_hi:[1,0,0]
  v_exp_f32 v200, v200
  v_exp_f32 v201, v201
  buffer_load_dwordx4 v6, s[8:11], s3 offen offset:2048 nt lds
  v_exp_f32 v202, v202
  v_exp_f32 v203, v203
  v_exp_f32 v204, v204
  v_exp_f32 v205, v205
  v_exp_f32 v206, v206
  v_exp_f32 v207, v207
  v_cvt_pk_bf16_f32 v108, v200, v201
  v_cvt_pk_bf16_f32 v109, v202, v203
  buffer_load_dwordx4 v7, s[8:11], s3 offen offset:3072 nt lds
  v_cvt_pk_bf16_f32 v110, v204, v205
  v_cvt_pk_bf16_f32 v111, v206, v207
  v_pk_add_f32 v[200:201], v[200:201], v[202:203]
  v_pk_add_f32 v[204:205], v[204:205], v[206:207]
  v_pk_add_f32 v[200:201], v[200:201], v[204:205]
  v_pk_add_f32 v[198:199], v[198:199], v[200:201]
  v_pk_fma_f32 v[200:201], v[124:125], s[66:67], v[196:197] op_sel_hi:[1,0,0]
  v_pk_fma_f32 v[202:203], v[126:127], s[66:67], v[196:197] op_sel_hi:[1,0,0]
  s_add_u32 m0, s56, 0
  s_add_u32 s3, s55, 3145728
  buffer_load_dwordx4 v6, s[8:11], s3 offen offset:0 nt lds
  v_pk_fma_f32 v[204:205], v[128:129], s[66:67], v[196:197] op_sel_hi:[1,0,0]
  v_pk_fma_f32 v[206:207], v[130:131], s[66:67], v[196:197] op_sel_hi:[1,0,0]
  v_exp_f32 v200, v200
  v_exp_f32 v201, v201
  v_exp_f32 v202, v202
  v_exp_f32 v203, v203
  v_exp_f32 v204, v204
  v_exp_f32 v205, v205
  v_exp_f32 v206, v206
  buffer_load_dwordx4 v7, s[8:11], s3 offen offset:1024 nt lds
  v_exp_f32 v207, v207
  v_cvt_pk_bf16_f32 v112, v200, v201
  v_cvt_pk_bf16_f32 v113, v202, v203
  v_cvt_pk_bf16_f32 v114, v204, v205
  v_cvt_pk_bf16_f32 v115, v206, v207
  v_pk_add_f32 v[200:201], v[200:201], v[202:203]
  v_pk_add_f32 v[204:205], v[204:205], v[206:207]
  v_pk_add_f32 v[200:201], v[200:201], v[204:205]
  buffer_load_dwordx4 v6, s[8:11], s3 offen offset:2048 nt lds
  v_pk_add_f32 v[198:199], v[198:199], v[200:201]
  v_pk_fma_f32 v[200:201], v[132:133], s[66:67], v[196:197] op_sel_hi:[1,0,0]
  v_pk_fma_f32 v[202:203], v[134:135], s[66:67], v[196:197] op_sel_hi:[1,0,0]
  v_pk_fma_f32 v[204:205], v[136:137], s[66:67], v[196:197] op_sel_hi:[1,0,0]
  v_pk_fma_f32 v[206:207], v[138:139], s[66:67], v[196:197] op_sel_hi:[1,0,0]
  v_exp_f32 v200, v200
  v_exp_f32 v201, v201
  v_exp_f32 v202, v202
  v_exp_f32 v203, v203
  buffer_load_dwordx4 v7, s[8:11], s3 offen offset:3072 nt lds
  v_exp_f32 v204, v204
  v_exp_f32 v205, v205
  v_exp_f32 v206, v206
  v_exp_f32 v207, v207
  v_cvt_pk_bf16_f32 v116, v200, v201
  v_cvt_pk_bf16_f32 v117, v202, v203
  v_cvt_pk_bf16_f32 v118, v204, v205
  v_cvt_pk_bf16_f32 v119, v206, v207
  s_add_u32 m0, s56, 4096
  s_add_u32 s3, s55, 3670016
  buffer_load_dwordx4 v6, s[8:11], s3 offen offset:0 nt lds
  v_pk_add_f32 v[200:201], v[200:201], v[202:203]
  v_pk_add_f32 v[204:205], v[204:205], v[206:207]
  v_pk_add_f32 v[200:201], v[200:201], v[204:205]
  v_pk_add_f32 v[198:199], v[198:199], v[200:201]
  v_pk_fma_f32 v[200:201], v[140:141], s[66:67], v[196:197] op_sel_hi:[1,0,0]
  v_pk_fma_f32 v[202:203], v[142:143], s[66:67], v[196:197] op_sel_hi:[1,0,0]
  v_pk_fma_f32 v[204:205], v[144:145], s[66:67], v[196:197] op_sel_hi:[1,0,0]
  v_pk_fma_f32 v[206:207], v[146:147], s[66:67], v[196:197] op_sel_hi:[1,0,0]
  buffer_load_dwordx4 v7, s[8:11], s3 offen offset:1024 nt lds
  v_exp_f32 v200, v200
  v_exp_f32 v201, v201
  v_exp_f32 v202, v202
  v_exp_f32 v203, v203
  v_exp_f32 v204, v204
  v_exp_f32 v205, v205
  v_exp_f32 v206, v206
  v_exp_f32 v207, v207
  v_cvt_pk_bf16_f32 v120, v200, v201
  buffer_load_dwordx4 v6, s[8:11], s3 offen offset:2048 nt lds
  v_cvt_pk_bf16_f32 v121, v202, v203
  v_cvt_pk_bf16_f32 v122, v204, v205
  v_cvt_pk_bf16_f32 v123, v206, v207
  v_pk_add_f32 v[200:201], v[200:201], v[202:203]
  v_pk_add_f32 v[204:205], v[204:205], v[206:207]
  v_pk_add_f32 v[200:201], v[200:201], v[204:205]
  v_pk_add_f32 v[198:199], v[198:199], v[200:201]
  v_pk_fma_f32 v[200:201], v[148:149], s[66:67], v[196:197] op_sel_hi:[1,0,0]
  buffer_load_dwordx4 v7, s[8:11], s3 offen offset:3072 nt lds
  v_pk_fma_f32 v[202:203], v[150:151], s[66:67], v[196:197] op_sel_hi:[1,0,0]
  v_pk_fma_f32 v[204:205], v[152:153], s[66:67], v[196:197] op_sel_hi:[1,0,0]
  v_pk_fma_f32 v[206:207], v[154:155], s[66:67], v[196:197] op_sel_hi:[1,0,0]
  v_exp_f32 v200, v200
  v_exp_f32 v201, v201
  v_exp_f32 v202, v202
  v_exp_f32 v203, v203
  v_exp_f32 v204, v204
  v_exp_f32 v205, v205
  v_exp_f32 v206, v206
  v_exp_f32 v207, v207
  v_cvt_pk_bf16_f32 v124, v200, v201
  v_cvt_pk_bf16_f32 v125, v202, v203
  v_cvt_pk_bf16_f32 v126, v204, v205
  v_cvt_pk_bf16_f32 v127, v206, v207
  v_pk_add_f32 v[200:201], v[200:201], v[202:203]
  v_pk_add_f32 v[204:205], v[204:205], v[206:207]
  v_pk_add_f32 v[200:201], v[200:201], v[204:205]
  v_pk_add_f32 v[198:199], v[198:199], v[200:201]
  v_pk_fma_f32 v[200:201], v[156:157], s[66:67], v[196:197] op_sel_hi:[1,0,0]
  v_pk_fma_f32 v[202:203], v[158:159], s[66:67], v[196:197] op_sel_hi:[1,0,0]
  v_pk_fma_f32 v[204:205], v[160:161], s[66:67], v[196:197] op_sel_hi:[1,0,0]
  v_pk_fma_f32 v[206:207], v[162:163], s[66:67], v[196:197] op_sel_hi:[1,0,0]
  v_exp_f32 v200, v200
  v_exp_f32 v201, v201
  v_exp_f32 v202, v202
  v_exp_f32 v203, v203
  v_exp_f32 v204, v204
  v_exp_f32 v205, v205
  v_exp_f32 v206, v206
  v_exp_f32 v207, v207
  v_cvt_pk_bf16_f32 v128, v200, v201
  v_cvt_pk_bf16_f32 v129, v202, v203
  v_cvt_pk_bf16_f32 v130, v204, v205
  v_cvt_pk_bf16_f32 v131, v206, v207
  v_pk_add_f32 v[200:201], v[200:201], v[202:203]
  v_pk_add_f32 v[204:205], v[204:205], v[206:207]
  v_pk_add_f32 v[200:201], v[200:201], v[204:205]
  v_pk_add_f32 v[198:199], v[198:199], v[200:201]
  v_add_f32 v76, v198, v199
  v_mov_b32 v197, v76
  s_nop 1
  v_permlane16_swap_b32 v76, v197
  v_add_f32 v76, v76, v197
  v_mov_b32 v197, v76
  s_nop 1
  v_permlane32_swap_b32 v76, v197
  v_add_f32 v76, v76, v197
  v_lshlrev_b32 v197, 2, v32
  s_lshl_b32 s59, s52, 6
  s_add_u32 s59, s59, 135424
  v_add_u32 v198, s59, v197
  ds_write_b32 v198, v76
  s_waitcnt vmcnt(28) lgkmcnt(0)
  ds_read_b64_tr_b16 a[128:129], v14 offset:8192
  ds_read_b64_tr_b16 a[132:133], v15 offset:8192
  ds_read_b64_tr_b16 a[136:137], v16 offset:8192
  ds_read_b64_tr_b16 a[140:141], v17 offset:8192
  ds_read_b64_tr_b16 a[144:145], v18 offset:8192
  ds_read_b64_tr_b16 a[148:149], v19 offset:8192
  ds_read_b64_tr_b16 a[152:153], v20 offset:8192
  ds_read_b64_tr_b16 a[156:157], v21 offset:8192
  s_waitcnt vmcnt(24) lgkmcnt(0)
  ds_read_b64_tr_b16 a[130:131], v14 offset:12288
  ds_read_b64_tr_b16 a[134:135], v15 offset:12288
  ds_read_b64_tr_b16 a[138:139], v16 offset:12288
  ds_read_b64_tr_b16 a[142:143], v17 offset:12288
  ds_read_b64_tr_b16 a[146:147], v18 offset:12288
  ds_read_b64_tr_b16 a[150:151], v19 offset:12288
  ds_read_b64_tr_b16 a[154:155], v20 offset:12288
  ds_read_b64_tr_b16 a[158:159], v21 offset:12288
  s_waitcnt vmcnt(20) lgkmcnt(0)
  ds_read_b64_tr_b16 a[160:161], v14 offset:16384
  ds_read_b64_tr_b16 a[164:165], v15 offset:16384
  ds_read_b64_tr_b16 a[168:169], v16 offset:16384
  ds_read_b64_tr_b16 a[172:173], v17 offset:16384
  ds_read_b64_tr_b16 a[176:177], v18 offset:16384
  ds_read_b64_tr_b16 a[180:181], v19 offset:16384
  ds_read_b64_tr_b16 a[184:185], v20 offset:16384
  ds_read_b64_tr_b16 a[188:189], v21 offset:16384
  v_mfma_f32_16x16x32_bf16 v[164:167], a[128:131], v[100:103], 0
  v_mfma_f32_16x16x32_bf16 v[168:171], a[132:135], v[100:103], 0
  v_mfma_f32_16x16x32_bf16 v[172:175], a[136:139], v[100:103], 0
  v_mfma_f32_16x16x32_bf16 v[176:179], a[140:143], v[100:103], 0
  v_mfma_f32_16x16x32_bf16 v[180:183], a[144:147], v[100:103], 0
  v_mfma_f32_16x16x32_bf16 v[184:187], a[148:151], v[100:103], 0
  v_mfma_f32_16x16x32_bf16 v[188:191], a[152:155], v[100:103], 0
  v_mfma_f32_16x16x32_bf16 v[192:195], a[156:159], v[100:103], 0
  s_waitcnt vmcnt(16) lgkmcnt(0)
  ds_read_b64_tr_b16 a[162:163], v14 offset:20480
  ds_read_b64_tr_b16 a[166:167], v15 offset:20480
  ds_read_b64_tr_b16 a[170:171], v16 offset:20480
  ds_read_b64_tr_b16 a[174:175], v17 offset:20480
  ds_read_b64_tr_b16 a[178:179], v18 offset:20480
  ds_read_b64_tr_b16 a[182:183], v19 offset:20480
  ds_read_b64_tr_b16 a[186:187], v20 offset:20480
  ds_read_b64_tr_b16 a[190:191], v21 offset:20480
  s_add_u32 s96, s97, 262144
  v_pk_mul_f32 v[148:149], s[96:97], v[40:41] op_sel_hi:[0,1]
  v_pk_mul_f32 v[150:151], s[96:97], v[42:43] op_sel_hi:[0,1]
  v_pk_mul_f32 v[152:153], s[96:97], v[44:45] op_sel_hi:[0,1]
  v_pk_mul_f32 v[154:155], s[96:97], v[46:47] op_sel_hi:[0,1]
  v_pk_mul_f32 v[156:157], s[96:97], v[48:49] op_sel_hi:[0,1]
  v_pk_mul_f32 v[158:159], s[96:97], v[50:51] op_sel_hi:[0,1]
  v_pk_mul_f32 v[160:161], s[96:97], v[52:53] op_sel_hi:[0,1]
  v_cvt_pk_bf16_f32 v148, 0, v148
  v_cvt_pk_bf16_f32 v149, 0, v149
  v_cvt_pk_bf16_f32 v150, 0, v150
  v_cvt_pk_bf16_f32 v151, 0, v151
  v_cvt_pk_bf16_f32 v152, 0, v152
  v_cvt_pk_bf16_f32 v153, 0, v153
  v_cvt_pk_bf16_f32 v154, 0, v154
  v_cvt_pk_bf16_f32 v155, 0, v155
  v_cvt_pk_bf16_f32 v156, 0, v156
  v_cvt_pk_bf16_f32 v157, 0, v157
  v_cvt_pk_bf16_f32 v158, 0, v158
  v_cvt_pk_bf16_f32 v159, 0, v159
  v_cvt_pk_bf16_f32 v160, 0, v160
  v_cvt_pk_bf16_f32 v161, 0, v161
  v_pk_add_f32 v[196:197], v[54:55], v[148:149]
  v_pk_add_f32 v[198:199], v[56:57], v[150:151]
  v_pk_add_f32 v[200:201], v[58:59], v[152:153]
  v_pk_add_f32 v[202:203], v[60:61], v[154:155]
  v_pk_add_f32 v[204:205], v[62:63], v[156:157]
  v_pk_add_f32 v[206:207], v[64:65], v[158:159]
  v_pk_add_f32 v[208:209], v[66:67], v[160:161]
  v_cvt_pk_bf16_f32 v196, 0, v196
  v_cvt_pk_bf16_f32 v197, 0, v197
  v_cvt_pk_bf16_f32 v198, 0, v198
  v_cvt_pk_bf16_f32 v199, 0, v199
  v_cvt_pk_bf16_f32 v200, 0, v200
  v_cvt_pk_bf16_f32 v201, 0, v201
  v_cvt_pk_bf16_f32 v202, 0, v202
  v_cvt_pk_bf16_f32 v203, 0, v203
  v_cvt_pk_bf16_f32 v204, 0, v204
  v_cvt_pk_bf16_f32 v205, 0, v205
  v_cvt_pk_bf16_f32 v206, 0, v206
  v_cvt_pk_bf16_f32 v207, 0, v207
  v_cvt_pk_bf16_f32 v208, 0, v208
  v_cvt_pk_bf16_f32 v209, 0, v209
  v_pk_mul_f32 v[210:211], v[196:197], v[196:197]
  v_pk_mul_f32 v[212:213], v[198:199], v[198:199]
  v_pk_mul_f32 v[214:215], v[200:201], v[200:201]
  v_pk_mul_f32 v[216:217], v[202:203], v[202:203]
  v_pk_mul_f32 v[218:219], v[204:205], v[204:205]
  v_pk_mul_f32 v[220:221], v[206:207], v[206:207]
  v_pk_mul_f32 v[222:223], v[208:209], v[208:209]
  v_pk_fma_f32 v[210:211], v[210:211], s[100:101], v[36:37] op_sel_hi:[1,0,1]
  v_pk_fma_f32 v[212:213], v[212:213], s[100:101], v[36:37] op_sel_hi:[1,0,1]
  v_pk_fma_f32 v[214:215], v[214:215], s[100:101], v[36:37] op_sel_hi:[1,0,1]
  v_pk_fma_f32 v[216:217], v[216:217], s[100:101], v[36:37] op_sel_hi:[1,0,1]
  v_pk_fma_f32 v[218:219], v[218:219], s[100:101], v[36:37] op_sel_hi:[1,0,1]
  v_pk_fma_f32 v[220:221], v[220:221], s[100:101], v[36:37] op_sel_hi:[1,0,1]
  v_pk_fma_f32 v[222:223], v[222:223], s[100:101], v[36:37] op_sel_hi:[1,0,1]
  v_pk_mul_f32 v[210:211], v[210:211], v[196:197]
  v_pk_mul_f32 v[212:213], v[212:213], v[198:199]
  v_pk_mul_f32 v[214:215], v[214:215], v[200:201]
  v_pk_mul_f32 v[216:217], v[216:217], v[202:203]
  v_pk_mul_f32 v[218:219], v[218:219], v[204:205]
  v_pk_mul_f32 v[220:221], v[220:221], v[206:207]
  v_pk_mul_f32 v[222:223], v[222:223], v[208:209]
  v_exp_f32 v210, v210
  v_exp_f32 v211, v211
  v_exp_f32 v212, v212
  v_exp_f32 v213, v213
  v_exp_f32 v214, v214
  v_exp_f32 v215, v215
  v_exp_f32 v216, v216
  v_exp_f32 v217, v217
  v_exp_f32 v218, v218
  v_exp_f32 v219, v219
  v_exp_f32 v220, v220
  v_exp_f32 v221, v221
  v_exp_f32 v222, v222
  v_exp_f32 v223, v223
  v_pk_add_f32 v[210:211], v[210:211], v[38:39]
  v_pk_add_f32 v[212:213], v[212:213], v[38:39]
  v_pk_add_f32 v[214:215], v[214:215], v[38:39]
  v_pk_add_f32 v[216:217], v[216:217], v[38:39]
  v_pk_add_f32 v[218:219], v[218:219], v[38:39]
  v_pk_add_f32 v[220:221], v[220:221], v[38:39]
  v_pk_add_f32 v[222:223], v[222:223], v[38:39]
  v_rcp_f32 v210, v210
  v_rcp_f32 v211, v211
  v_rcp_f32 v212, v212
  v_rcp_f32 v213, v213
  v_rcp_f32 v214, v214
  v_rcp_f32 v215, v215
  v_rcp_f32 v216, v216
  v_rcp_f32 v217, v217
  v_rcp_f32 v218, v218
  v_rcp_f32 v219, v219
  v_rcp_f32 v220, v220
  v_rcp_f32 v221, v221
  v_rcp_f32 v222, v222
  v_rcp_f32 v223, v223
  v_pk_mul_f32 v[210:211], v[210:211], v[196:197]
  v_pk_mul_f32 v[212:213], v[212:213], v[198:199]
  v_pk_mul_f32 v[214:215], v[214:215], v[200:201]
  v_pk_mul_f32 v[216:217], v[216:217], v[202:203]
  v_pk_mul_f32 v[218:219], v[218:219], v[204:205]
  v_pk_mul_f32 v[220:221], v[220:221], v[206:207]
  v_pk_mul_f32 v[222:223], v[222:223], v[208:209]
  v_cvt_pk_bf16_f32 v196, v210, v211
  v_cvt_pk_bf16_f32 v197, v212, v213
  v_cvt_pk_bf16_f32 v198, v214, v215
  v_cvt_pk_bf16_f32 v199, v216, v217
  v_cvt_pk_bf16_f32 v200, v218, v219
  v_cvt_pk_bf16_f32 v201, v220, v221
  v_cvt_pk_bf16_f32 v202, v222, v223
  v_dot2c_f32_bf16 v88, v196, v68
  v_dot2c_f32_bf16 v88, v197, v69
  v_dot2c_f32_bf16 v88, v198, v70
  v_dot2c_f32_bf16 v88, v199, v71
  v_dot2c_f32_bf16 v88, v200, v72
  v_dot2c_f32_bf16 v88, v201, v73
  v_dot2c_f32_bf16 v88, v202, v74
  s_waitcnt vmcnt(12) lgkmcnt(0)
  ds_read_b64_tr_b16 a[128:129], v14 offset:24576
  ds_read_b64_tr_b16 a[132:133], v15 offset:24576
  ds_read_b64_tr_b16 a[136:137], v16 offset:24576
  ds_read_b64_tr_b16 a[140:141], v17 offset:24576
  ds_read_b64_tr_b16 a[144:145], v18 offset:24576
  ds_read_b64_tr_b16 a[148:149], v19 offset:24576
  ds_read_b64_tr_b16 a[152:153], v20 offset:24576
  ds_read_b64_tr_b16 a[156:157], v21 offset:24576
  s_add_u32 m0, s56, 8192
  s_add_u32 s3, s55, 4194304
  buffer_load_dwordx4 v6, s[8:11], s3 offen offset:0 nt lds
  v_pk_add_f32 v[196:197], v[54:55], v[148:149] neg_lo:[0,1] neg_hi:[0,1]
  v_pk_add_f32 v[198:199], v[56:57], v[150:151] neg_lo:[0,1] neg_hi:[0,1]
  v_pk_add_f32 v[200:201], v[58:59], v[152:153] neg_lo:[0,1] neg_hi:[0,1]
  v_pk_add_f32 v[202:203], v[60:61], v[154:155] neg_lo:[0,1] neg_hi:[0,1]
  v_pk_add_f32 v[204:205], v[62:63], v[156:157] neg_lo:[0,1] neg_hi:[0,1]
  v_mfma_f32_16x16x32_bf16 v[164:167], a[160:163], v[104:107], v[164:167]
  v_pk_add_f32 v[206:207], v[64:65], v[158:159] neg_lo:[0,1] neg_hi:[0,1]
  v_pk_add_f32 v[208:209], v[66:67], v[160:161] neg_lo:[0,1] neg_hi:[0,1]
  v_cvt_pk_bf16_f32 v196, 0, v196
  v_cvt_pk_bf16_f32 v197, 0, v197
  v_cvt_pk_bf16_f32 v198, 0, v198
  v_cvt_pk_bf16_f32 v199, 0, v199
  v_mfma_f32_16x16x32_bf16 v[168:171], a[164:167], v[104:107], v[168:171]
  v_cvt_pk_bf16_f32 v200, 0, v200
  v_cvt_pk_bf16_f32 v201, 0, v201
  v_cvt_pk_bf16_f32 v202, 0, v202
  v_cvt_pk_bf16_f32 v203, 0, v203
  v_cvt_pk_bf16_f32 v204, 0, v204
  v_cvt_pk_bf16_f32 v205, 0, v205
  buffer_load_dwordx4 v7, s[8:11], s3 offen offset:1024 nt lds
  v_cvt_pk_bf16_f32 v206, 0, v206
  v_cvt_pk_bf16_f32 v207, 0, v207
  v_cvt_pk_bf16_f32 v208, 0, v208
  v_cvt_pk_bf16_f32 v209, 0, v209
  v_pk_mul_f32 v[210:211], v[196:197], v[196:197]
  v_mfma_f32_16x16x32_bf16 v[172:175], a[168:171], v[104:107], v[172:175]
  v_pk_mul_f32 v[212:213], v[198:199], v[198:199]
  v_pk_mul_f32 v[214:215], v[200:201], v[200:201]
  v_pk_mul_f32 v[216:217], v[202:203], v[202:203]
  v_pk_mul_f32 v[218:219], v[204:205], v[204:205]
  v_pk_mul_f32 v[220:221], v[206:207], v[206:207]
  v_pk_mul_f32 v[222:223], v[208:209], v[208:209]
  v_mfma_f32_16x16x32_bf16 v[176:179], a[172:175], v[104:107], v[176:179]
  v_pk_fma_f32 v[210:211], v[210:211], s[100:101], v[36:37] op_sel_hi:[1,0,1]
  v_pk_fma_f32 v[212:213], v[212:213], s[100:101], v[36:37] op_sel_hi:[1,0,1]
  v_pk_fma_f32 v[214:215], v[214:215], s[100:101], v[36:37] op_sel_hi:[1,0,1]
  v_pk_fma_f32 v[216:217], v[216:217], s[100:101], v[36:37] op_sel_hi:[1,0,1]
  v_pk_fma_f32 v[218:219], v[218:219], s[100:101], v[36:37] op_sel_hi:[1,0,1]
  v_pk_fma_f32 v[220:221], v[220:221], s[100:101], v[36:37] op_sel_hi:[1,0,1]
  buffer_load_dwordx4 v6, s[8:11], s3 offen offset:2048 nt lds
  v_pk_fma_f32 v[222:223], v[222:223], s[100:101], v[36:37] op_sel_hi:[1,0,1]
  v_pk_mul_f32 v[210:211], v[210:211], v[196:197]
  v_pk_mul_f32 v[212:213], v[212:213], v[198:199]
  v_pk_mul_f32 v[214:215], v[214:215], v[200:201]
  v_pk_mul_f32 v[216:217], v[216:217], v[202:203]
  v_pk_mul_f32 v[218:219], v[218:219], v[204:205]
  v_mfma_f32_16x16x32_bf16 v[180:183], a[176:179], v[104:107], v[180:183]
  v_pk_mul_f32 v[220:221], v[220:221], v[206:207]
  v_pk_mul_f32 v[222:223], v[222:223], v[208:209]
  v_exp_f32 v210, v210
  v_exp_f32 v211, v211
  v_exp_f32 v212, v212
  v_mfma_f32_16x16x32_bf16 v[184:187], a[180:183], v[104:107], v[184:187]
  v_exp_f32 v213, v213
  v_exp_f32 v214, v214
  v_exp_f32 v215, v215
  v_exp_f32 v216, v216
  v_exp_f32 v217, v217
  v_exp_f32 v218, v218
  buffer_load_dwordx4 v7, s[8:11], s3 offen offset:3072 nt lds
  v_exp_f32 v219, v219
  v_exp_f32 v220, v220
  v_exp_f32 v221, v221
  v_exp_f32 v222, v222
  v_exp_f32 v223, v223
  v_pk_add_f32 v[210:211], v[210:211], v[38:39]
  v_mfma_f32_16x16x32_bf16 v[188:191], a[184:187], v[104:107], v[188:191]
  v_pk_add_f32 v[212:213], v[212:213], v[38:39]
  v_pk_add_f32 v[214:215], v[214:215], v[38:39]
  v_pk_add_f32 v[216:217], v[216:217], v[38:39]
  v_pk_add_f32 v[218:219], v[218:219], v[38:39]
  v_pk_add_f32 v[220:221], v[220:221], v[38:39]
  v_mfma_f32_16x16x32_bf16 v[192:195], a[188:191], v[104:107], v[192:195]
  v_pk_add_f32 v[222:223], v[222:223], v[38:39]
  v_rcp_f32 v210, v210
  v_rcp_f32 v211, v211
  v_rcp_f32 v212, v212
  v_rcp_f32 v213, v213
  v_rcp_f32 v214, v214
  v_rcp_f32 v215, v215
  v_rcp_f32 v216, v216
  v_rcp_f32 v217, v217
  v_rcp_f32 v218, v218
  v_rcp_f32 v219, v219
  v_rcp_f32 v220, v220
  v_rcp_f32 v221, v221
  v_rcp_f32 v222, v222
  v_rcp_f32 v223, v223
  v_pk_mul_f32 v[210:211], v[210:211], v[196:197]
  v_pk_mul_f32 v[212:213], v[212:213], v[198:199]
  v_pk_mul_f32 v[214:215], v[214:215], v[200:201]
  v_pk_mul_f32 v[216:217], v[216:217], v[202:203]
  v_pk_mul_f32 v[218:219], v[218:219], v[204:205]
  v_pk_mul_f32 v[220:221], v[220:221], v[206:207]
  v_pk_mul_f32 v[222:223], v[222:223], v[208:209]
  v_cvt_pk_bf16_f32 v196, v210, v211
  v_cvt_pk_bf16_f32 v197, v212, v213
  v_cvt_pk_bf16_f32 v198, v214, v215
  v_cvt_pk_bf16_f32 v199, v216, v217
  v_cvt_pk_bf16_f32 v200, v218, v219
  v_cvt_pk_bf16_f32 v201, v220, v221
  v_cvt_pk_bf16_f32 v202, v222, v223
  v_dot2c_f32_bf16 v96, v196, v68
  v_dot2c_f32_bf16 v96, v197, v69
  v_dot2c_f32_bf16 v96, v198, v70
  v_dot2c_f32_bf16 v96, v199, v71
  v_dot2c_f32_bf16 v96, v200, v72
  v_dot2c_f32_bf16 v96, v201, v73
  v_dot2c_f32_bf16 v96, v202, v74
  s_waitcnt vmcnt(12) lgkmcnt(0)
  ds_read_b64_tr_b16 a[130:131], v14 offset:28672
  ds_read_b64_tr_b16 a[134:135], v15 offset:28672
  ds_read_b64_tr_b16 a[138:139], v16 offset:28672
  ds_read_b64_tr_b16 a[142:143], v17 offset:28672
  ds_read_b64_tr_b16 a[146:147], v18 offset:28672
  ds_read_b64_tr_b16 a[150:151], v19 offset:28672
  ds_read_b64_tr_b16 a[154:155], v20 offset:28672
  ds_read_b64_tr_b16 a[158:159], v21 offset:28672
  s_add_u32 m0, s56, 12288
  s_add_u32 s3, s55, 4718592
  buffer_load_dwordx4 v6, s[8:11], s3 offen offset:0 nt lds
  s_add_u32 s96, s97, 327680
  v_pk_mul_f32 v[148:149], s[96:97], v[40:41] op_sel_hi:[0,1]
  v_pk_mul_f32 v[150:151], s[96:97], v[42:43] op_sel_hi:[0,1]
  v_pk_mul_f32 v[152:153], s[96:97], v[44:45] op_sel_hi:[0,1]
  v_pk_mul_f32 v[154:155], s[96:97], v[46:47] op_sel_hi:[0,1]
  v_pk_mul_f32 v[156:157], s[96:97], v[48:49] op_sel_hi:[0,1]
  v_pk_mul_f32 v[158:159], s[96:97], v[50:51] op_sel_hi:[0,1]
  v_pk_mul_f32 v[160:161], s[96:97], v[52:53] op_sel_hi:[0,1]
  v_cvt_pk_bf16_f32 v148, 0, v148
  v_cvt_pk_bf16_f32 v149, 0, v149
  v_cvt_pk_bf16_f32 v150, 0, v150
  v_cvt_pk_bf16_f32 v151, 0, v151
  v_cvt_pk_bf16_f32 v152, 0, v152
  v_cvt_pk_bf16_f32 v153, 0, v153
  v_cvt_pk_bf16_f32 v154, 0, v154
  v_cvt_pk_bf16_f32 v155, 0, v155
  v_cvt_pk_bf16_f32 v156, 0, v156
  v_cvt_pk_bf16_f32 v157, 0, v157
  v_cvt_pk_bf16_f32 v158, 0, v158
  v_cvt_pk_bf16_f32 v159, 0, v159
  v_cvt_pk_bf16_f32 v160, 0, v160
  buffer_load_dwordx4 v7, s[8:11], s3 offen offset:1024 nt lds
  v_cvt_pk_bf16_f32 v161, 0, v161
  v_pk_add_f32 v[196:197], v[54:55], v[148:149]
  v_pk_add_f32 v[198:199], v[56:57], v[150:151]
  v_pk_add_f32 v[200:201], v[58:59], v[152:153]
  v_pk_add_f32 v[202:203], v[60:61], v[154:155]
  v_pk_add_f32 v[204:205], v[62:63], v[156:157]
  v_pk_add_f32 v[206:207], v[64:65], v[158:159]
  v_pk_add_f32 v[208:209], v[66:67], v[160:161]
  v_cvt_pk_bf16_f32 v196, 0, v196
  v_cvt_pk_bf16_f32 v197, 0, v197
  v_cvt_pk_bf16_f32 v198, 0, v198
  v_cvt_pk_bf16_f32 v199, 0, v199
  v_cvt_pk_bf16_f32 v200, 0, v200
  v_cvt_pk_bf16_f32 v201, 0, v201
  v_cvt_pk_bf16_f32 v202, 0, v202
  v_cvt_pk_bf16_f32 v203, 0, v203
  v_cvt_pk_bf16_f32 v204, 0, v204
  v_cvt_pk_bf16_f32 v205, 0, v205
  v_cvt_pk_bf16_f32 v206, 0, v206
  v_cvt_pk_bf16_f32 v207, 0, v207
  v_cvt_pk_bf16_f32 v208, 0, v208
  buffer_load_dwordx4 v6, s[8:11], s3 offen offset:2048 nt lds
  v_cvt_pk_bf16_f32 v209, 0, v209
  v_pk_mul_f32 v[210:211], v[196:197], v[196:197]
  v_pk_mul_f32 v[212:213], v[198:199], v[198:199]
  v_pk_mul_f32 v[214:215], v[200:201], v[200:201]
  v_pk_mul_f32 v[216:217], v[202:203], v[202:203]
  v_pk_mul_f32 v[218:219], v[204:205], v[204:205]
  v_pk_mul_f32 v[220:221], v[206:207], v[206:207]
  v_pk_mul_f32 v[222:223], v[208:209], v[208:209]
  v_pk_fma_f32 v[210:211], v[210:211], s[100:101], v[36:37] op_sel_hi:[1,0,1]
  v_pk_fma_f32 v[212:213], v[212:213], s[100:101], v[36:37] op_sel_hi:[1,0,1]
  v_pk_fma_f32 v[214:215], v[214:215], s[100:101], v[36:37] op_sel_hi:[1,0,1]
  v_pk_fma_f32 v[216:217], v[216:217], s[100:101], v[36:37] op_sel_hi:[1,0,1]
  v_pk_fma_f32 v[218:219], v[218:219], s[100:101], v[36:37] op_sel_hi:[1,0,1]
  v_pk_fma_f32 v[220:221], v[220:221], s[100:101], v[36:37] op_sel_hi:[1,0,1]
  v_pk_fma_f32 v[222:223], v[222:223], s[100:101], v[36:37] op_sel_hi:[1,0,1]
  v_pk_mul_f32 v[210:211], v[210:211], v[196:197]
  v_pk_mul_f32 v[212:213], v[212:213], v[198:199]
  v_pk_mul_f32 v[214:215], v[214:215], v[200:201]
  v_pk_mul_f32 v[216:217], v[216:217], v[202:203]
  v_pk_mul_f32 v[218:219], v[218:219], v[204:205]
  v_pk_mul_f32 v[220:221], v[220:221], v[206:207]
  buffer_load_dwordx4 v7, s[8:11], s3 offen offset:3072 nt lds
  v_pk_mul_f32 v[222:223], v[222:223], v[208:209]
  v_exp_f32 v210, v210
  v_exp_f32 v211, v211
  v_exp_f32 v212, v212
  v_exp_f32 v213, v213
  v_exp_f32 v214, v214
  v_exp_f32 v215, v215
  v_exp_f32 v216, v216
  v_exp_f32 v217, v217
  v_exp_f32 v218, v218
  v_exp_f32 v219, v219
  v_exp_f32 v220, v220
  v_exp_f32 v221, v221
  v_exp_f32 v222, v222
  v_exp_f32 v223, v223
  v_pk_add_f32 v[210:211], v[210:211], v[38:39]
  v_pk_add_f32 v[212:213], v[212:213], v[38:39]
  v_pk_add_f32 v[214:215], v[214:215], v[38:39]
  v_pk_add_f32 v[216:217], v[216:217], v[38:39]
  v_pk_add_f32 v[218:219], v[218:219], v[38:39]
  v_pk_add_f32 v[220:221], v[220:221], v[38:39]
  v_pk_add_f32 v[222:223], v[222:223], v[38:39]
  v_rcp_f32 v210, v210
  v_rcp_f32 v211, v211
  v_rcp_f32 v212, v212
  v_rcp_f32 v213, v213
  v_rcp_f32 v214, v214
  v_rcp_f32 v215, v215
  v_rcp_f32 v216, v216
  v_rcp_f32 v217, v217
  v_rcp_f32 v218, v218
  v_rcp_f32 v219, v219
  v_rcp_f32 v220, v220
  v_rcp_f32 v221, v221
  v_rcp_f32 v222, v222
  v_rcp_f32 v223, v223
  v_pk_mul_f32 v[210:211], v[210:211], v[196:197]
  v_pk_mul_f32 v[212:213], v[212:213], v[198:199]
  v_pk_mul_f32 v[214:215], v[214:215], v[200:201]
  v_pk_mul_f32 v[216:217], v[216:217], v[202:203]
  v_pk_mul_f32 v[218:219], v[218:219], v[204:205]
  v_pk_mul_f32 v[220:221], v[220:221], v[206:207]
  v_pk_mul_f32 v[222:223], v[222:223], v[208:209]
  v_cvt_pk_bf16_f32 v196, v210, v211
  v_cvt_pk_bf16_f32 v197, v212, v213
  v_cvt_pk_bf16_f32 v198, v214, v215
  v_cvt_pk_bf16_f32 v199, v216, v217
  v_cvt_pk_bf16_f32 v200, v218, v219
  v_cvt_pk_bf16_f32 v201, v220, v221
  v_cvt_pk_bf16_f32 v202, v222, v223
  v_dot2c_f32_bf16 v89, v196, v68
  v_dot2c_f32_bf16 v89, v197, v69
  v_dot2c_f32_bf16 v89, v198, v70
  v_dot2c_f32_bf16 v89, v199, v71
  v_dot2c_f32_bf16 v89, v200, v72
  v_dot2c_f32_bf16 v89, v201, v73
  v_dot2c_f32_bf16 v89, v202, v74
  s_waitcnt vmcnt(12) lgkmcnt(0)
  ds_read_b64_tr_b16 a[160:161], v14 offset:0
  ds_read_b64_tr_b16 a[164:165], v15 offset:0
  ds_read_b64_tr_b16 a[168:169], v16 offset:0
  ds_read_b64_tr_b16 a[172:173], v17 offset:0
  ds_read_b64_tr_b16 a[176:177], v18 offset:0
  ds_read_b64_tr_b16 a[180:181], v19 offset:0
  ds_read_b64_tr_b16 a[184:185], v20 offset:0
  ds_read_b64_tr_b16 a[188:189], v21 offset:0
  s_add_u32 m0, s56, 16384
  s_add_u32 s3, s55, 5242880
  buffer_load_dwordx4 v6, s[8:11], s3 offen offset:0 nt lds
  v_pk_add_f32 v[196:197], v[54:55], v[148:149] neg_lo:[0,1] neg_hi:[0,1]
  v_pk_add_f32 v[198:199], v[56:57], v[150:151] neg_lo:[0,1] neg_hi:[0,1]
  v_pk_add_f32 v[200:201], v[58:59], v[152:153] neg_lo:[0,1] neg_hi:[0,1]
  v_pk_add_f32 v[202:203], v[60:61], v[154:155] neg_lo:[0,1] neg_hi:[0,1]
  v_pk_add_f32 v[204:205], v[62:63], v[156:157] neg_lo:[0,1] neg_hi:[0,1]
  v_mfma_f32_16x16x32_bf16 v[164:167], a[128:131], v[108:111], v[164:167]
  v_pk_add_f32 v[206:207], v[64:65], v[158:159] neg_lo:[0,1] neg_hi:[0,1]
  v_pk_add_f32 v[208:209], v[66:67], v[160:161] neg_lo:[0,1] neg_hi:[0,1]
  v_cvt_pk_bf16_f32 v196, 0, v196
  v_cvt_pk_bf16_f32 v197, 0, v197
  v_cvt_pk_bf16_f32 v198, 0, v198
  v_mfma_f32_16x16x32_bf16 v[168:171], a[132:135], v[108:111], v[168:171]
  v_cvt_pk_bf16_f32 v199, 0, v199
  v_cvt_pk_bf16_f32 v200, 0, v200
  v_cvt_pk_bf16_f32 v201, 0, v201
  v_cvt_pk_bf16_f32 v202, 0, v202
  v_cvt_pk_bf16_f32 v203, 0, v203
  buffer_load_dwordx4 v7, s[8:11], s3 offen offset:1024 nt lds
  v_cvt_pk_bf16_f32 v204, 0, v204
  v_cvt_pk_bf16_f32 v205, 0, v205
  v_cvt_pk_bf16_f32 v206, 0, v206
  v_cvt_pk_bf16_f32 v207, 0, v207
  v_cvt_pk_bf16_f32 v208, 0, v208
  v_cvt_pk_bf16_f32 v209, 0, v209
  v_mfma_f32_16x16x32_bf16 v[172:175], a[136:139], v[108:111], v[172:175]
  v_pk_mul_f32 v[210:211], v[196:197], v[196:197]
  v_pk_mul_f32 v[212:213], v[198:199], v[198:199]
  v_pk_mul_f32 v[214:215], v[200:201], v[200:201]
  v_pk_mul_f32 v[216:217], v[202:203], v[202:203]
  v_pk_mul_f32 v[218:219], v[204:205], v[204:205]
  v_mfma_f32_16x16x32_bf16 v[176:179], a[140:143], v[108:111], v[176:179]
  v_pk_mul_f32 v[220:221], v[206:207], v[206:207]
  v_pk_mul_f32 v[222:223], v[208:209], v[208:209]
  v_pk_fma_f32 v[210:211], v[210:211], s[100:101], v[36:37] op_sel_hi:[1,0,1]
  v_pk_fma_f32 v[212:213], v[212:213], s[100:101], v[36:37] op_sel_hi:[1,0,1]
  v_pk_fma_f32 v[214:215], v[214:215], s[100:101], v[36:37] op_sel_hi:[1,0,1]
  buffer_load_dwordx4 v6, s[8:11], s3 offen offset:2048 nt lds
  v_pk_fma_f32 v[216:217], v[216:217], s[100:101], v[36:37] op_sel_hi:[1,0,1]
  v_pk_fma_f32 v[218:219], v[218:219], s[100:101], v[36:37] op_sel_hi:[1,0,1]
  v_pk_fma_f32 v[220:221], v[220:221], s[100:101], v[36:37] op_sel_hi:[1,0,1]
  v_pk_fma_f32 v[222:223], v[222:223], s[100:101], v[36:37] op_sel_hi:[1,0,1]
  v_pk_mul_f32 v[210:211], v[210:211], v[196:197]
  v_mfma_f32_16x16x32_bf16 v[180:183], a[144:147], v[108:111], v[180:183]
  v_pk_mul_f32 v[212:213], v[212:213], v[198:199]
  v_pk_mul_f32 v[214:215], v[214:215], v[200:201]
  v_pk_mul_f32 v[216:217], v[216:217], v[202:203]
  v_pk_mul_f32 v[218:219], v[218:219], v[204:205]
  v_pk_mul_f32 v[220:221], v[220:221], v[206:207]
  v_pk_mul_f32 v[222:223], v[222:223], v[208:209]
  v_mfma_f32_16x16x32_bf16 v[184:187], a[148:151], v[108:111], v[184:187]
  v_exp_f32 v210, v210
  v_exp_f32 v211, v211
  v_exp_f32 v212, v212
  v_exp_f32 v213, v213
  v_exp_f32 v214, v214
  buffer_load_dwordx4 v7, s[8:11], s3 offen offset:3072 nt lds
  v_exp_f32 v215, v215
  v_exp_f32 v216, v216
  v_exp_f32 v217, v217
  v_exp_f32 v218, v218
  v_exp_f32 v219, v219
  v_mfma_f32_16x16x32_bf16 v[188:191], a[152:155], v[108:111], v[188:191]
  v_exp_f32 v220, v220
  v_exp_f32 v221, v221
  v_exp_f32 v222, v222
  v_exp_f32 v223, v223
  v_pk_add_f32 v[210:211], v[210:211], v[38:39]
  v_pk_add_f32 v[212:213], v[212:213], v[38:39]
  v_mfma_f32_16x16x32_bf16 v[192:195], a[156:159], v[108:111], v[192:195]
  v_pk_add_f32 v[214:215], v[214:215], v[38:39]
  v_pk_add_f32 v[216:217], v[216:217], v[38:39]
  v_pk_add_f32 v[218:219], v[218:219], v[38:39]
  v_pk_add_f32 v[220:221], v[220:221], v[38:39]
  v_pk_add_f32 v[222:223], v[222:223], v[38:39]
  s_and_b32 s59, s94, 0xfe
  s_cmp_eq_u32 s59, 128
  s_mov_b32 s59, 0
  v_lshl_add_u32 v236, v1, 2, s59
  buffer_load_dword v237, v236, s[28:31], 0 offen sc1
  v_rcp_f32 v210, v210
  v_rcp_f32 v211, v211
  v_rcp_f32 v212, v212
  v_rcp_f32 v213, v213
  v_rcp_f32 v214, v214
  v_rcp_f32 v215, v215
  v_rcp_f32 v216, v216
  v_rcp_f32 v217, v217
  v_rcp_f32 v218, v218
  v_rcp_f32 v219, v219
  v_rcp_f32 v220, v220
  v_rcp_f32 v221, v221
  v_rcp_f32 v222, v222
  v_rcp_f32 v223, v223
  v_pk_mul_f32 v[210:211], v[210:211], v[196:197]
  v_pk_mul_f32 v[212:213], v[212:213], v[198:199]
  v_pk_mul_f32 v[214:215], v[214:215], v[200:201]
  v_pk_mul_f32 v[216:217], v[216:217], v[202:203]
  v_pk_mul_f32 v[218:219], v[218:219], v[204:205]
  v_pk_mul_f32 v[220:221], v[220:221], v[206:207]
  v_pk_mul_f32 v[222:223], v[222:223], v[208:209]
  v_cvt_pk_bf16_f32 v196, v210, v211
  v_cvt_pk_bf16_f32 v197, v212, v213
  v_cvt_pk_bf16_f32 v198, v214, v215
  v_cvt_pk_bf16_f32 v199, v216, v217
  v_cvt_pk_bf16_f32 v200, v218, v219
  v_cvt_pk_bf16_f32 v201, v220, v221
  v_cvt_pk_bf16_f32 v202, v222, v223
  v_dot2c_f32_bf16 v97, v196, v68
  v_dot2c_f32_bf16 v97, v197, v69
  v_dot2c_f32_bf16 v97, v198, v70
  v_dot2c_f32_bf16 v97, v199, v71
  v_dot2c_f32_bf16 v97, v200, v72
  v_dot2c_f32_bf16 v97, v201, v73
  v_dot2c_f32_bf16 v97, v202, v74
  s_waitcnt vmcnt(13) lgkmcnt(0)
  ds_read_b64_tr_b16 a[162:163], v14 offset:4096
  ds_read_b64_tr_b16 a[166:167], v15 offset:4096
  ds_read_b64_tr_b16 a[170:171], v16 offset:4096
  ds_read_b64_tr_b16 a[174:175], v17 offset:4096
  ds_read_b64_tr_b16 a[178:179], v18 offset:4096
  ds_read_b64_tr_b16 a[182:183], v19 offset:4096
  ds_read_b64_tr_b16 a[186:187], v20 offset:4096
  ds_read_b64_tr_b16 a[190:191], v21 offset:4096
  s_add_u32 m0, s56, 20480
  s_add_u32 s3, s55, 5767168
  buffer_load_dwordx4 v6, s[8:11], s3 offen offset:0 nt lds
  s_add_u32 s96, s97, 393216
  v_pk_mul_f32 v[148:149], s[96:97], v[40:41] op_sel_hi:[0,1]
  v_pk_mul_f32 v[150:151], s[96:97], v[42:43] op_sel_hi:[0,1]
  v_pk_mul_f32 v[152:153], s[96:97], v[44:45] op_sel_hi:[0,1]
  v_pk_mul_f32 v[154:155], s[96:97], v[46:47] op_sel_hi:[0,1]
  v_pk_mul_f32 v[156:157], s[96:97], v[48:49] op_sel_hi:[0,1]
  v_pk_mul_f32 v[158:159], s[96:97], v[50:51] op_sel_hi:[0,1]
  v_pk_mul_f32 v[160:161], s[96:97], v[52:53] op_sel_hi:[0,1]
  v_cvt_pk_bf16_f32 v148, 0, v148
  v_cvt_pk_bf16_f32 v149, 0, v149
  v_cvt_pk_bf16_f32 v150, 0, v150
  v_cvt_pk_bf16_f32 v151, 0, v151
  v_cvt_pk_bf16_f32 v152, 0, v152
  v_cvt_pk_bf16_f32 v153, 0, v153
  v_cvt_pk_bf16_f32 v154, 0, v154
  v_cvt_pk_bf16_f32 v155, 0, v155
  v_cvt_pk_bf16_f32 v156, 0, v156
  v_cvt_pk_bf16_f32 v157, 0, v157
  v_cvt_pk_bf16_f32 v158, 0, v158
  v_cvt_pk_bf16_f32 v159, 0, v159
  v_cvt_pk_bf16_f32 v160, 0, v160
  buffer_load_dwordx4 v7, s[8:11], s3 offen offset:1024 nt lds
  v_cvt_pk_bf16_f32 v161, 0, v161
  v_pk_add_f32 v[196:197], v[54:55], v[148:149]
  v_pk_add_f32 v[198:199], v[56:57], v[150:151]
  v_pk_add_f32 v[200:201], v[58:59], v[152:153]
  v_pk_add_f32 v[202:203], v[60:61], v[154:155]
  v_pk_add_f32 v[204:205], v[62:63], v[156:157]
  v_pk_add_f32 v[206:207], v[64:65], v[158:159]
  v_pk_add_f32 v[208:209], v[66:67], v[160:161]
  v_cvt_pk_bf16_f32 v196, 0, v196
  v_cvt_pk_bf16_f32 v197, 0, v197
  v_cvt_pk_bf16_f32 v198, 0, v198
  v_cvt_pk_bf16_f32 v199, 0, v199
  v_cvt_pk_bf16_f32 v200, 0, v200
  v_cvt_pk_bf16_f32 v201, 0, v201
  v_cvt_pk_bf16_f32 v202, 0, v202
  v_cvt_pk_bf16_f32 v203, 0, v203
  v_cvt_pk_bf16_f32 v204, 0, v204
  v_cvt_pk_bf16_f32 v205, 0, v205
  v_cvt_pk_bf16_f32 v206, 0, v206
  v_cvt_pk_bf16_f32 v207, 0, v207
  v_cvt_pk_bf16_f32 v208, 0, v208
  buffer_load_dwordx4 v6, s[8:11], s3 offen offset:2048 nt lds
  v_cvt_pk_bf16_f32 v209, 0, v209
  v_pk_mul_f32 v[210:211], v[196:197], v[196:197]
  v_pk_mul_f32 v[212:213], v[198:199], v[198:199]
  v_pk_mul_f32 v[214:215], v[200:201], v[200:201]
  v_pk_mul_f32 v[216:217], v[202:203], v[202:203]
  v_pk_mul_f32 v[218:219], v[204:205], v[204:205]
  v_pk_mul_f32 v[220:221], v[206:207], v[206:207]
  v_pk_mul_f32 v[222:223], v[208:209], v[208:209]
  v_pk_fma_f32 v[210:211], v[210:211], s[100:101], v[36:37] op_sel_hi:[1,0,1]
  v_pk_fma_f32 v[212:213], v[212:213], s[100:101], v[36:37] op_sel_hi:[1,0,1]
  v_pk_fma_f32 v[214:215], v[214:215], s[100:101], v[36:37] op_sel_hi:[1,0,1]
  v_pk_fma_f32 v[216:217], v[216:217], s[100:101], v[36:37] op_sel_hi:[1,0,1]
  v_pk_fma_f32 v[218:219], v[218:219], s[100:101], v[36:37] op_sel_hi:[1,0,1]
  v_pk_fma_f32 v[220:221], v[220:221], s[100:101], v[36:37] op_sel_hi:[1,0,1]
  v_pk_fma_f32 v[222:223], v[222:223], s[100:101], v[36:37] op_sel_hi:[1,0,1]
  v_pk_mul_f32 v[210:211], v[210:211], v[196:197]
  v_pk_mul_f32 v[212:213], v[212:213], v[198:199]
  v_pk_mul_f32 v[214:215], v[214:215], v[200:201]
  v_pk_mul_f32 v[216:217], v[216:217], v[202:203]
  v_pk_mul_f32 v[218:219], v[218:219], v[204:205]
  v_pk_mul_f32 v[220:221], v[220:221], v[206:207]
  buffer_load_dwordx4 v7, s[8:11], s3 offen offset:3072 nt lds
  v_pk_mul_f32 v[222:223], v[222:223], v[208:209]
  v_exp_f32 v210, v210
  v_exp_f32 v211, v211
  v_exp_f32 v212, v212
  v_exp_f32 v213, v213
  v_exp_f32 v214, v214
  v_exp_f32 v215, v215
  v_exp_f32 v216, v216
  v_exp_f32 v217, v217
  v_exp_f32 v218, v218
  v_exp_f32 v219, v219
  v_exp_f32 v220, v220
  v_exp_f32 v221, v221
  v_exp_f32 v222, v222
  v_exp_f32 v223, v223
  v_pk_add_f32 v[210:211], v[210:211], v[38:39]
  v_pk_add_f32 v[212:213], v[212:213], v[38:39]
  v_pk_add_f32 v[214:215], v[214:215], v[38:39]
  v_pk_add_f32 v[216:217], v[216:217], v[38:39]
  v_pk_add_f32 v[218:219], v[218:219], v[38:39]
  v_pk_add_f32 v[220:221], v[220:221], v[38:39]
  v_pk_add_f32 v[222:223], v[222:223], v[38:39]
  v_rcp_f32 v210, v210
  v_rcp_f32 v211, v211
  v_rcp_f32 v212, v212
  v_rcp_f32 v213, v213
  v_rcp_f32 v214, v214
  v_rcp_f32 v215, v215
  v_rcp_f32 v216, v216
  v_rcp_f32 v217, v217
  v_rcp_f32 v218, v218
  v_rcp_f32 v219, v219
  v_rcp_f32 v220, v220
  v_rcp_f32 v221, v221
  v_rcp_f32 v222, v222
  v_rcp_f32 v223, v223
  v_pk_mul_f32 v[210:211], v[210:211], v[196:197]
  v_pk_mul_f32 v[212:213], v[212:213], v[198:199]
  v_pk_mul_f32 v[214:215], v[214:215], v[200:201]
  v_pk_mul_f32 v[216:217], v[216:217], v[202:203]
  v_pk_mul_f32 v[218:219], v[218:219], v[204:205]
  v_pk_mul_f32 v[220:221], v[220:221], v[206:207]
  v_pk_mul_f32 v[222:223], v[222:223], v[208:209]
  v_cvt_pk_bf16_f32 v196, v210, v211
  v_cvt_pk_bf16_f32 v197, v212, v213
  v_cvt_pk_bf16_f32 v198, v214, v215
  v_cvt_pk_bf16_f32 v199, v216, v217
  v_cvt_pk_bf16_f32 v200, v218, v219
  v_cvt_pk_bf16_f32 v201, v220, v221
  v_cvt_pk_bf16_f32 v202, v222, v223
  v_dot2c_f32_bf16 v90, v196, v68
  v_dot2c_f32_bf16 v90, v197, v69
  v_dot2c_f32_bf16 v90, v198, v70
  v_dot2c_f32_bf16 v90, v199, v71
  v_dot2c_f32_bf16 v90, v200, v72
  v_dot2c_f32_bf16 v90, v201, v73
  v_dot2c_f32_bf16 v90, v202, v74
  s_waitcnt vmcnt(13) lgkmcnt(0)
  ds_read_b64_tr_b16 a[128:129], v14 offset:8192
  ds_read_b64_tr_b16 a[132:133], v15 offset:8192
  ds_read_b64_tr_b16 a[136:137], v16 offset:8192
  ds_read_b64_tr_b16 a[140:141], v17 offset:8192
  ds_read_b64_tr_b16 a[144:145], v18 offset:8192
  ds_read_b64_tr_b16 a[148:149], v19 offset:8192
  ds_read_b64_tr_b16 a[152:153], v20 offset:8192
  ds_read_b64_tr_b16 a[156:157], v21 offset:8192
  s_add_u32 m0, s56, 24576
  s_add_u32 s3, s55, 6291456
  buffer_load_dwordx4 v6, s[8:11], s3 offen offset:0 nt lds
  v_pk_add_f32 v[196:197], v[54:55], v[148:149] neg_lo:[0,1] neg_hi:[0,1]
  v_pk_add_f32 v[198:199], v[56:57], v[150:151] neg_lo:[0,1] neg_hi:[0,1]
  v_pk_add_f32 v[200:201], v[58:59], v[152:153] neg_lo:[0,1] neg_hi:[0,1]
  v_pk_add_f32 v[202:203], v[60:61], v[154:155] neg_lo:[0,1] neg_hi:[0,1]
  v_pk_add_f32 v[204:205], v[62:63], v[156:157] neg_lo:[0,1] neg_hi:[0,1]
  v_mfma_f32_16x16x32_bf16 v[164:167], a[160:163], v[112:115], v[164:167]
  v_pk_add_f32 v[206:207], v[64:65], v[158:159] neg_lo:[0,1] neg_hi:[0,1]
  v_pk_add_f32 v[208:209], v[66:67], v[160:161] neg_lo:[0,1] neg_hi:[0,1]
  v_cvt_pk_bf16_f32 v196, 0, v196
  v_cvt_pk_bf16_f32 v197, 0, v197
  v_cvt_pk_bf16_f32 v198, 0, v198
  v_cvt_pk_bf16_f32 v199, 0, v199
  v_mfma_f32_16x16x32_bf16 v[168:171], a[164:167], v[112:115], v[168:171]
  v_cvt_pk_bf16_f32 v200, 0, v200
  v_cvt_pk_bf16_f32 v201, 0, v201
  v_cvt_pk_bf16_f32 v202, 0, v202
  v_cvt_pk_bf16_f32 v203, 0, v203
  v_cvt_pk_bf16_f32 v204, 0, v204
  v_cvt_pk_bf16_f32 v205, 0, v205
  buffer_load_dwordx4 v7, s[8:11], s3 offen offset:1024 nt lds
  v_cvt_pk_bf16_f32 v206, 0, v206
  v_cvt_pk_bf16_f32 v207, 0, v207
  v_cvt_pk_bf16_f32 v208, 0, v208
  v_cvt_pk_bf16_f32 v209, 0, v209
  v_pk_mul_f32 v[210:211], v[196:197], v[196:197]
  v_mfma_f32_16x16x32_bf16 v[172:175], a[168:171], v[112:115], v[172:175]
  v_pk_mul_f32 v[212:213], v[198:199], v[198:199]
  v_pk_mul_f32 v[214:215], v[200:201], v[200:201]
  v_pk_mul_f32 v[216:217], v[202:203], v[202:203]
  v_pk_mul_f32 v[218:219], v[204:205], v[204:205]
  v_pk_mul_f32 v[220:221], v[206:207], v[206:207]
  v_pk_mul_f32 v[222:223], v[208:209], v[208:209]
  v_mfma_f32_16x16x32_bf16 v[176:179], a[172:175], v[112:115], v[176:179]
  v_pk_fma_f32 v[210:211], v[210:211], s[100:101], v[36:37] op_sel_hi:[1,0,1]
  v_pk_fma_f32 v[212:213], v[212:213], s[100:101], v[36:37] op_sel_hi:[1,0,1]
  v_pk_fma_f32 v[214:215], v[214:215], s[100:101], v[36:37] op_sel_hi:[1,0,1]
  v_pk_fma_f32 v[216:217], v[216:217], s[100:101], v[36:37] op_sel_hi:[1,0,1]
  v_pk_fma_f32 v[218:219], v[218:219], s[100:101], v[36:37] op_sel_hi:[1,0,1]
  v_pk_fma_f32 v[220:221], v[220:221], s[100:101], v[36:37] op_sel_hi:[1,0,1]
  buffer_load_dwordx4 v6, s[8:11], s3 offen offset:2048 nt lds
  v_pk_fma_f32 v[222:223], v[222:223], s[100:101], v[36:37] op_sel_hi:[1,0,1]
  v_pk_mul_f32 v[210:211], v[210:211], v[196:197]
  v_pk_mul_f32 v[212:213], v[212:213], v[198:199]
  v_pk_mul_f32 v[214:215], v[214:215], v[200:201]
  v_pk_mul_f32 v[216:217], v[216:217], v[202:203]
  v_pk_mul_f32 v[218:219], v[218:219], v[204:205]
  v_mfma_f32_16x16x32_bf16 v[180:183], a[176:179], v[112:115], v[180:183]
  v_pk_mul_f32 v[220:221], v[220:221], v[206:207]
  v_pk_mul_f32 v[222:223], v[222:223], v[208:209]
  v_exp_f32 v210, v210
  v_exp_f32 v211, v211
  v_exp_f32 v212, v212
  v_mfma_f32_16x16x32_bf16 v[184:187], a[180:183], v[112:115], v[184:187]
  v_exp_f32 v213, v213
  v_exp_f32 v214, v214
  v_exp_f32 v215, v215
  v_exp_f32 v216, v216
  v_exp_f32 v217, v217
  v_exp_f32 v218, v218
  buffer_load_dwordx4 v7, s[8:11], s3 offen offset:3072 nt lds
  v_exp_f32 v219, v219
  v_exp_f32 v220, v220
  v_exp_f32 v221, v221
  v_exp_f32 v222, v222
  v_exp_f32 v223, v223
  v_pk_add_f32 v[210:211], v[210:211], v[38:39]
  v_mfma_f32_16x16x32_bf16 v[188:191], a[184:187], v[112:115], v[188:191]
  v_pk_add_f32 v[212:213], v[212:213], v[38:39]
  v_pk_add_f32 v[214:215], v[214:215], v[38:39]
  v_pk_add_f32 v[216:217], v[216:217], v[38:39]
  v_pk_add_f32 v[218:219], v[218:219], v[38:39]
  v_pk_add_f32 v[220:221], v[220:221], v[38:39]
  v_mfma_f32_16x16x32_bf16 v[192:195], a[188:191], v[112:115], v[192:195]
  v_pk_add_f32 v[222:223], v[222:223], v[38:39]
  v_rcp_f32 v210, v210
  v_rcp_f32 v211, v211
  v_rcp_f32 v212, v212
  v_rcp_f32 v213, v213
  v_rcp_f32 v214, v214
  v_rcp_f32 v215, v215
  v_rcp_f32 v216, v216
  v_rcp_f32 v217, v217
  v_rcp_f32 v218, v218
  v_rcp_f32 v219, v219
  v_rcp_f32 v220, v220
  v_rcp_f32 v221, v221
  v_rcp_f32 v222, v222
  v_rcp_f32 v223, v223
  v_pk_mul_f32 v[210:211], v[210:211], v[196:197]
  v_pk_mul_f32 v[212:213], v[212:213], v[198:199]
  v_pk_mul_f32 v[214:215], v[214:215], v[200:201]
  v_pk_mul_f32 v[216:217], v[216:217], v[202:203]
  v_pk_mul_f32 v[218:219], v[218:219], v[204:205]
  v_pk_mul_f32 v[220:221], v[220:221], v[206:207]
  v_pk_mul_f32 v[222:223], v[222:223], v[208:209]
  v_cvt_pk_bf16_f32 v196, v210, v211
  v_cvt_pk_bf16_f32 v197, v212, v213
  v_cvt_pk_bf16_f32 v198, v214, v215
  v_cvt_pk_bf16_f32 v199, v216, v217
  v_cvt_pk_bf16_f32 v200, v218, v219
  v_cvt_pk_bf16_f32 v201, v220, v221
  v_cvt_pk_bf16_f32 v202, v222, v223
  v_dot2c_f32_bf16 v98, v196, v68
  v_dot2c_f32_bf16 v98, v197, v69
  v_dot2c_f32_bf16 v98, v198, v70
  v_dot2c_f32_bf16 v98, v199, v71
  v_dot2c_f32_bf16 v98, v200, v72
  v_dot2c_f32_bf16 v98, v201, v73
  v_dot2c_f32_bf16 v98, v202, v74
  s_waitcnt vmcnt(13) lgkmcnt(0)
  ds_read_b64_tr_b16 a[130:131], v14 offset:12288
  ds_read_b64_tr_b16 a[134:135], v15 offset:12288
  ds_read_b64_tr_b16 a[138:139], v16 offset:12288
  ds_read_b64_tr_b16 a[142:143], v17 offset:12288
  ds_read_b64_tr_b16 a[146:147], v18 offset:12288
  ds_read_b64_tr_b16 a[150:151], v19 offset:12288
  ds_read_b64_tr_b16 a[154:155], v20 offset:12288
  ds_read_b64_tr_b16 a[158:159], v21 offset:12288
  s_add_u32 m0, s56, 28672
  s_add_u32 s3, s55, 6815744
  buffer_load_dwordx4 v6, s[8:11], s3 offen offset:0 nt lds
  s_add_u32 s96, s97, 458752
  v_pk_mul_f32 v[148:149], s[96:97], v[40:41] op_sel_hi:[0,1]
  v_pk_mul_f32 v[150:151], s[96:97], v[42:43] op_sel_hi:[0,1]
  v_pk_mul_f32 v[152:153], s[96:97], v[44:45] op_sel_hi:[0,1]
  v_pk_mul_f32 v[154:155], s[96:97], v[46:47] op_sel_hi:[0,1]
  v_pk_mul_f32 v[156:157], s[96:97], v[48:49] op_sel_hi:[0,1]
  v_pk_mul_f32 v[158:159], s[96:97], v[50:51] op_sel_hi:[0,1]
  v_pk_mul_f32 v[160:161], s[96:97], v[52:53] op_sel_hi:[0,1]
  v_cvt_pk_bf16_f32 v148, 0, v148
  v_cvt_pk_bf16_f32 v149, 0, v149
  v_cvt_pk_bf16_f32 v150, 0, v150
  v_cvt_pk_bf16_f32 v151, 0, v151
  v_cvt_pk_bf16_f32 v152, 0, v152
  v_cvt_pk_bf16_f32 v153, 0, v153
  v_cvt_pk_bf16_f32 v154, 0, v154
  v_cvt_pk_bf16_f32 v155, 0, v155
  v_cvt_pk_bf16_f32 v156, 0, v156
  v_cvt_pk_bf16_f32 v157, 0, v157
  v_cvt_pk_bf16_f32 v158, 0, v158
  v_cvt_pk_bf16_f32 v159, 0, v159
  v_cvt_pk_bf16_f32 v160, 0, v160
  buffer_load_dwordx4 v7, s[8:11], s3 offen offset:1024 nt lds
  v_cvt_pk_bf16_f32 v161, 0, v161
  v_pk_add_f32 v[196:197], v[54:55], v[148:149]
  v_pk_add_f32 v[198:199], v[56:57], v[150:151]
  v_pk_add_f32 v[200:201], v[58:59], v[152:153]
  v_pk_add_f32 v[202:203], v[60:61], v[154:155]
  v_pk_add_f32 v[204:205], v[62:63], v[156:157]
  v_pk_add_f32 v[206:207], v[64:65], v[158:159]
  v_pk_add_f32 v[208:209], v[66:67], v[160:161]
  v_cvt_pk_bf16_f32 v196, 0, v196
  v_cvt_pk_bf16_f32 v197, 0, v197
  v_cvt_pk_bf16_f32 v198, 0, v198
  v_cvt_pk_bf16_f32 v199, 0, v199
  v_cvt_pk_bf16_f32 v200, 0, v200
  v_cvt_pk_bf16_f32 v201, 0, v201
  v_cvt_pk_bf16_f32 v202, 0, v202
  v_cvt_pk_bf16_f32 v203, 0, v203
  v_cvt_pk_bf16_f32 v204, 0, v204
  v_cvt_pk_bf16_f32 v205, 0, v205
  v_cvt_pk_bf16_f32 v206, 0, v206
  v_cvt_pk_bf16_f32 v207, 0, v207
  v_cvt_pk_bf16_f32 v208, 0, v208
  buffer_load_dwordx4 v6, s[8:11], s3 offen offset:2048 nt lds
  v_cvt_pk_bf16_f32 v209, 0, v209
  v_pk_mul_f32 v[210:211], v[196:197], v[196:197]
  v_pk_mul_f32 v[212:213], v[198:199], v[198:199]
  v_pk_mul_f32 v[214:215], v[200:201], v[200:201]
  v_pk_mul_f32 v[216:217], v[202:203], v[202:203]
  v_pk_mul_f32 v[218:219], v[204:205], v[204:205]
  v_pk_mul_f32 v[220:221], v[206:207], v[206:207]
  v_pk_mul_f32 v[222:223], v[208:209], v[208:209]
  v_pk_fma_f32 v[210:211], v[210:211], s[100:101], v[36:37] op_sel_hi:[1,0,1]
  v_pk_fma_f32 v[212:213], v[212:213], s[100:101], v[36:37] op_sel_hi:[1,0,1]
  v_pk_fma_f32 v[214:215], v[214:215], s[100:101], v[36:37] op_sel_hi:[1,0,1]
  v_pk_fma_f32 v[216:217], v[216:217], s[100:101], v[36:37] op_sel_hi:[1,0,1]
  v_pk_fma_f32 v[218:219], v[218:219], s[100:101], v[36:37] op_sel_hi:[1,0,1]
  v_pk_fma_f32 v[220:221], v[220:221], s[100:101], v[36:37] op_sel_hi:[1,0,1]
  v_pk_fma_f32 v[222:223], v[222:223], s[100:101], v[36:37] op_sel_hi:[1,0,1]
  v_pk_mul_f32 v[210:211], v[210:211], v[196:197]
  v_pk_mul_f32 v[212:213], v[212:213], v[198:199]
  v_pk_mul_f32 v[214:215], v[214:215], v[200:201]
  v_pk_mul_f32 v[216:217], v[216:217], v[202:203]
  v_pk_mul_f32 v[218:219], v[218:219], v[204:205]
  v_pk_mul_f32 v[220:221], v[220:221], v[206:207]
  buffer_load_dwordx4 v7, s[8:11], s3 offen offset:3072 nt lds
  v_pk_mul_f32 v[222:223], v[222:223], v[208:209]
  v_exp_f32 v210, v210
  v_exp_f32 v211, v211
  v_exp_f32 v212, v212
  v_exp_f32 v213, v213
  v_exp_f32 v214, v214
  v_exp_f32 v215, v215
  v_exp_f32 v216, v216
  v_exp_f32 v217, v217
  v_exp_f32 v218, v218
  v_exp_f32 v219, v219
  v_exp_f32 v220, v220
  v_exp_f32 v221, v221
  v_exp_f32 v222, v222
  v_exp_f32 v223, v223
  v_pk_add_f32 v[210:211], v[210:211], v[38:39]
  v_pk_add_f32 v[212:213], v[212:213], v[38:39]
  v_pk_add_f32 v[214:215], v[214:215], v[38:39]
  v_pk_add_f32 v[216:217], v[216:217], v[38:39]
  v_pk_add_f32 v[218:219], v[218:219], v[38:39]
  v_pk_add_f32 v[220:221], v[220:221], v[38:39]
  v_pk_add_f32 v[222:223], v[222:223], v[38:39]
  v_rcp_f32 v210, v210
  v_rcp_f32 v211, v211
  v_rcp_f32 v212, v212
  v_rcp_f32 v213, v213
  v_rcp_f32 v214, v214
  v_rcp_f32 v215, v215
  v_rcp_f32 v216, v216
  v_rcp_f32 v217, v217
  v_rcp_f32 v218, v218
  v_rcp_f32 v219, v219
  v_rcp_f32 v220, v220
  v_rcp_f32 v221, v221
  v_rcp_f32 v222, v222
  v_rcp_f32 v223, v223
  v_pk_mul_f32 v[210:211], v[210:211], v[196:197]
  v_pk_mul_f32 v[212:213], v[212:213], v[198:199]
  v_pk_mul_f32 v[214:215], v[214:215], v[200:201]
  v_pk_mul_f32 v[216:217], v[216:217], v[202:203]
  v_pk_mul_f32 v[218:219], v[218:219], v[204:205]
  v_pk_mul_f32 v[220:221], v[220:221], v[206:207]
  v_pk_mul_f32 v[222:223], v[222:223], v[208:209]
  v_cvt_pk_bf16_f32 v196, v210, v211
  v_cvt_pk_bf16_f32 v197, v212, v213
  v_cvt_pk_bf16_f32 v198, v214, v215
  v_cvt_pk_bf16_f32 v199, v216, v217
  v_cvt_pk_bf16_f32 v200, v218, v219
  v_cvt_pk_bf16_f32 v201, v220, v221
  v_cvt_pk_bf16_f32 v202, v222, v223
  v_dot2c_f32_bf16 v91, v196, v68
  v_dot2c_f32_bf16 v91, v197, v69
  v_dot2c_f32_bf16 v91, v198, v70
  v_dot2c_f32_bf16 v91, v199, v71
  v_dot2c_f32_bf16 v91, v200, v72
  v_dot2c_f32_bf16 v91, v201, v73
  v_dot2c_f32_bf16 v91, v202, v74
  s_waitcnt vmcnt(13) lgkmcnt(0)
  ds_read_b64_tr_b16 a[160:161], v14 offset:16384
  ds_read_b64_tr_b16 a[164:165], v15 offset:16384
  ds_read_b64_tr_b16 a[168:169], v16 offset:16384
  ds_read_b64_tr_b16 a[172:173], v17 offset:16384
  ds_read_b64_tr_b16 a[176:177], v18 offset:16384
  ds_read_b64_tr_b16 a[180:181], v19 offset:16384
  ds_read_b64_tr_b16 a[184:185], v20 offset:16384
  ds_read_b64_tr_b16 a[188:189], v21 offset:16384
  s_add_u32 m0, s56, 0
  s_add_u32 s3, s55, 7340032
  buffer_load_dwordx4 v6, s[8:11], s3 offen offset:0 nt lds
  v_pk_add_f32 v[196:197], v[54:55], v[148:149] neg_lo:[0,1] neg_hi:[0,1]
  v_pk_add_f32 v[198:199], v[56:57], v[150:151] neg_lo:[0,1] neg_hi:[0,1]
  v_pk_add_f32 v[200:201], v[58:59], v[152:153] neg_lo:[0,1] neg_hi:[0,1]
  v_pk_add_f32 v[202:203], v[60:61], v[154:155] neg_lo:[0,1] neg_hi:[0,1]
  v_pk_add_f32 v[204:205], v[62:63], v[156:157] neg_lo:[0,1] neg_hi:[0,1]
  v_mfma_f32_16x16x32_bf16 v[164:167], a[128:131], v[116:119], v[164:167]
  v_pk_add_f32 v[206:207], v[64:65], v[158:159] neg_lo:[0,1] neg_hi:[0,1]
  v_pk_add_f32 v[208:209], v[66:67], v[160:161] neg_lo:[0,1] neg_hi:[0,1]
  v_cvt_pk_bf16_f32 v196, 0, v196
  v_cvt_pk_bf16_f32 v197, 0, v197
  v_cvt_pk_bf16_f32 v198, 0, v198
  v_cvt_pk_bf16_f32 v199, 0, v199
  v_mfma_f32_16x16x32_bf16 v[168:171], a[132:135], v[116:119], v[168:171]
  v_cvt_pk_bf16_f32 v200, 0, v200
  v_cvt_pk_bf16_f32 v201, 0, v201
  v_cvt_pk_bf16_f32 v202, 0, v202
  v_cvt_pk_bf16_f32 v203, 0, v203
  v_cvt_pk_bf16_f32 v204, 0, v204
  v_cvt_pk_bf16_f32 v205, 0, v205
  buffer_load_dwordx4 v7, s[8:11], s3 offen offset:1024 nt lds
  v_cvt_pk_bf16_f32 v206, 0, v206
  v_cvt_pk_bf16_f32 v207, 0, v207
  v_cvt_pk_bf16_f32 v208, 0, v208
  v_cvt_pk_bf16_f32 v209, 0, v209
  v_pk_mul_f32 v[210:211], v[196:197], v[196:197]
  v_mfma_f32_16x16x32_bf16 v[172:175], a[136:139], v[116:119], v[172:175]
  v_pk_mul_f32 v[212:213], v[198:199], v[198:199]
  v_pk_mul_f32 v[214:215], v[200:201], v[200:201]
  v_pk_mul_f32 v[216:217], v[202:203], v[202:203]
  v_pk_mul_f32 v[218:219], v[204:205], v[204:205]
  v_pk_mul_f32 v[220:221], v[206:207], v[206:207]
  v_pk_mul_f32 v[222:223], v[208:209], v[208:209]
  v_mfma_f32_16x16x32_bf16 v[176:179], a[140:143], v[116:119], v[176:179]
  v_pk_fma_f32 v[210:211], v[210:211], s[100:101], v[36:37] op_sel_hi:[1,0,1]
  v_pk_fma_f32 v[212:213], v[212:213], s[100:101], v[36:37] op_sel_hi:[1,0,1]
  v_pk_fma_f32 v[214:215], v[214:215], s[100:101], v[36:37] op_sel_hi:[1,0,1]
  v_pk_fma_f32 v[216:217], v[216:217], s[100:101], v[36:37] op_sel_hi:[1,0,1]
  v_pk_fma_f32 v[218:219], v[218:219], s[100:101], v[36:37] op_sel_hi:[1,0,1]
  v_pk_fma_f32 v[220:221], v[220:221], s[100:101], v[36:37] op_sel_hi:[1,0,1]
  buffer_load_dwordx4 v6, s[8:11], s3 offen offset:2048 nt lds
  v_pk_fma_f32 v[222:223], v[222:223], s[100:101], v[36:37] op_sel_hi:[1,0,1]
  v_pk_mul_f32 v[210:211], v[210:211], v[196:197]
  v_pk_mul_f32 v[212:213], v[212:213], v[198:199]
  v_pk_mul_f32 v[214:215], v[214:215], v[200:201]
  v_pk_mul_f32 v[216:217], v[216:217], v[202:203]
  v_pk_mul_f32 v[218:219], v[218:219], v[204:205]
  v_mfma_f32_16x16x32_bf16 v[180:183], a[144:147], v[116:119], v[180:183]
  v_pk_mul_f32 v[220:221], v[220:221], v[206:207]
  v_pk_mul_f32 v[222:223], v[222:223], v[208:209]
  v_exp_f32 v210, v210
  v_exp_f32 v211, v211
  v_exp_f32 v212, v212
  v_mfma_f32_16x16x32_bf16 v[184:187], a[148:151], v[116:119], v[184:187]
  v_exp_f32 v213, v213
  v_exp_f32 v214, v214
  v_exp_f32 v215, v215
  v_exp_f32 v216, v216
  v_exp_f32 v217, v217
  v_exp_f32 v218, v218
  buffer_load_dwordx4 v7, s[8:11], s3 offen offset:3072 nt lds
  v_exp_f32 v219, v219
  v_exp_f32 v220, v220
  v_exp_f32 v221, v221
  v_exp_f32 v222, v222
  v_exp_f32 v223, v223
  v_pk_add_f32 v[210:211], v[210:211], v[38:39]
  v_mfma_f32_16x16x32_bf16 v[188:191], a[152:155], v[116:119], v[188:191]
  v_pk_add_f32 v[212:213], v[212:213], v[38:39]
  v_pk_add_f32 v[214:215], v[214:215], v[38:39]
  v_pk_add_f32 v[216:217], v[216:217], v[38:39]
  v_pk_add_f32 v[218:219], v[218:219], v[38:39]
  v_pk_add_f32 v[220:221], v[220:221], v[38:39]
  v_mfma_f32_16x16x32_bf16 v[192:195], a[156:159], v[116:119], v[192:195]
  v_pk_add_f32 v[222:223], v[222:223], v[38:39]
  v_rcp_f32 v210, v210
  v_rcp_f32 v211, v211
  v_rcp_f32 v212, v212
  v_rcp_f32 v213, v213
  v_rcp_f32 v214, v214
  v_rcp_f32 v215, v215
  v_rcp_f32 v216, v216
  v_rcp_f32 v217, v217
  v_rcp_f32 v218, v218
  v_rcp_f32 v219, v219
  v_rcp_f32 v220, v220
  v_rcp_f32 v221, v221
  v_rcp_f32 v222, v222
  v_rcp_f32 v223, v223
  v_pk_mul_f32 v[210:211], v[210:211], v[196:197]
  v_pk_mul_f32 v[212:213], v[212:213], v[198:199]
  v_pk_mul_f32 v[214:215], v[214:215], v[200:201]
  v_pk_mul_f32 v[216:217], v[216:217], v[202:203]
  v_pk_mul_f32 v[218:219], v[218:219], v[204:205]
  v_pk_mul_f32 v[220:221], v[220:221], v[206:207]
  v_pk_mul_f32 v[222:223], v[222:223], v[208:209]
  v_cvt_pk_bf16_f32 v196, v210, v211
  v_cvt_pk_bf16_f32 v197, v212, v213
  v_cvt_pk_bf16_f32 v198, v214, v215
  v_cvt_pk_bf16_f32 v199, v216, v217
  v_cvt_pk_bf16_f32 v200, v218, v219
  v_cvt_pk_bf16_f32 v201, v220, v221
  v_cvt_pk_bf16_f32 v202, v222, v223
  v_dot2c_f32_bf16 v99, v196, v68
  v_dot2c_f32_bf16 v99, v197, v69
  v_dot2c_f32_bf16 v99, v198, v70
  v_dot2c_f32_bf16 v99, v199, v71
  v_dot2c_f32_bf16 v99, v200, v72
  v_dot2c_f32_bf16 v99, v201, v73
  v_dot2c_f32_bf16 v99, v202, v74
  s_waitcnt vmcnt(12) lgkmcnt(0)
  ds_read_b64_tr_b16 a[162:163], v14 offset:20480
  ds_read_b64_tr_b16 a[166:167], v15 offset:20480
  ds_read_b64_tr_b16 a[170:171], v16 offset:20480
  ds_read_b64_tr_b16 a[174:175], v17 offset:20480
  ds_read_b64_tr_b16 a[178:179], v18 offset:20480
  ds_read_b64_tr_b16 a[182:183], v19 offset:20480
  ds_read_b64_tr_b16 a[186:187], v20 offset:20480
  ds_read_b64_tr_b16 a[190:191], v21 offset:20480
  s_add_u32 m0, s56, 4096
  s_add_u32 s3, s55, 7864320
  buffer_load_dwordx4 v6, s[8:11], s3 offen offset:0 nt lds
  buffer_load_dwordx4 v7, s[8:11], s3 offen offset:1024 nt lds
  buffer_load_dwordx4 v6, s[8:11], s3 offen offset:2048 nt lds
  buffer_load_dwordx4 v7, s[8:11], s3 offen offset:3072 nt lds
  v_permlane32_swap_b32 v84, v92
  v_permlane32_swap_b32 v85, v93
  v_permlane32_swap_b32 v86, v94
  v_permlane32_swap_b32 v87, v95
  v_permlane32_swap_b32 v88, v96
  v_permlane32_swap_b32 v89, v97
  v_permlane32_swap_b32 v90, v98
  v_permlane32_swap_b32 v91, v99
  v_add_f32 v84, v84, v92
  v_add_f32 v85, v85, v93
  v_add_f32 v86, v86, v94
  v_add_f32 v87, v87, v95
  v_add_f32 v88, v88, v96
  v_add_f32 v89, v89, v97
  v_add_f32 v90, v90, v98
  v_add_f32 v91, v91, v99
  v_permlane16_swap_b32 v84, v88
  v_permlane16_swap_b32 v85, v89
  v_permlane16_swap_b32 v86, v90
  v_permlane16_swap_b32 v87, v91
  v_add_f32 v84, v84, v88
  v_add_f32 v85, v85, v89
  v_add_f32 v86, v86, v90
  v_add_f32 v87, v87, v91
  v_add_f32_dpp v84, v84, v84 row_ror:8 row_mask:0xf bank_mask:0xf
  v_add_f32_dpp v85, v85, v85 row_ror:8 row_mask:0xf bank_mask:0xf
  v_add_f32_dpp v86, v86, v86 row_ror:8 row_mask:0xf bank_mask:0xf
  v_add_f32_dpp v87, v87, v87 row_ror:8 row_mask:0xf bank_mask:0xf
  v_add_f32_dpp v84, v84, v84 row_ror:4 row_mask:0xf bank_mask:0xf
  v_add_f32_dpp v85, v85, v85 row_ror:4 row_mask:0xf bank_mask:0xf
  v_add_f32_dpp v86, v86, v86 row_ror:4 row_mask:0xf bank_mask:0xf
  v_add_f32_dpp v87, v87, v87 row_ror:4 row_mask:0xf bank_mask:0xf
  v_add_f32_dpp v84, v84, v84 row_ror:2 row_mask:0xf bank_mask:0xf
  v_add_f32_dpp v85, v85, v85 row_ror:2 row_mask:0xf bank_mask:0xf
  v_add_f32_dpp v86, v86, v86 row_ror:2 row_mask:0xf bank_mask:0xf
  v_add_f32_dpp v87, v87, v87 row_ror:2 row_mask:0xf bank_mask:0xf
  v_add_f32_dpp v84, v84, v84 row_ror:1 row_mask:0xf bank_mask:0xf
  v_add_f32_dpp v85, v85, v85 row_ror:1 row_mask:0xf bank_mask:0xf
  v_add_f32_dpp v86, v86, v86 row_ror:1 row_mask:0xf bank_mask:0xf
  v_add_f32_dpp v87, v87, v87 row_ror:1 row_mask:0xf bank_mask:0xf
  v_lshlrev_b32 v196, 4, v33
  s_lshl_b32 s59, s52, 6
  s_add_u32 s59, s59, 135680
  v_add_u32 v196, s59, v196
  ds_write_b128 v196, v[84:87]
  s_waitcnt lgkmcnt(0)
  s_barrier
  v_lshlrev_b32 v196, 2, v32
  v_add_u32 v197, 135680, v196
  v_add_u32 v196, 135424, v196
  ds_read_b32 v200, v197 offset:0
  ds_read_b32 v204, v196 offset:0
  ds_read_b32 v201, v197 offset:64
  ds_read_b32 v205, v196 offset:64
  ds_read_b32 v202, v197 offset:128
  ds_read_b32 v206, v196 offset:128
  ds_read_b32 v203, v197 offset:192
  ds_read_b32 v207, v196 offset:192
  s_waitcnt lgkmcnt(0)
  v_add_f32 v200, v200, v201
  v_add_f32 v202, v202, v203
  v_add_f32 v200, v200, v202
  v_add_f32 v204, v204, v205
  v_add_f32 v206, v206, v207
  v_add_f32 v204, v204, v206
  v_cvt_pk_bf16_f32 v200, 0, v200
  v_add_f32 v200, v200, v77
  v_cvt_pk_bf16_f32 v200, 0, v200
  buffer_store_dword v200, v31, s[24:27], 0 offen sc1
  v_mov_b32 v208, v75
  v_mov_b32 v209, v204
  buffer_store_dwordx2 v[208:209], v28, s[24:27], 0 offen sc1
  s_waitcnt vmcnt(14) lgkmcnt(0)
  ds_read_b64_tr_b16 a[128:129], v14 offset:24576
  ds_read_b64_tr_b16 a[132:133], v15 offset:24576
  ds_read_b64_tr_b16 a[136:137], v16 offset:24576
  ds_read_b64_tr_b16 a[140:141], v17 offset:24576
  ds_read_b64_tr_b16 a[144:145], v18 offset:24576
  ds_read_b64_tr_b16 a[148:149], v19 offset:24576
  ds_read_b64_tr_b16 a[152:153], v20 offset:24576
  ds_read_b64_tr_b16 a[156:157], v21 offset:24576
  v_mfma_f32_16x16x32_bf16 v[164:167], a[160:163], v[120:123], v[164:167]
  v_mfma_f32_16x16x32_bf16 v[168:171], a[164:167], v[120:123], v[168:171]
  v_mfma_f32_16x16x32_bf16 v[172:175], a[168:171], v[120:123], v[172:175]
  v_mfma_f32_16x16x32_bf16 v[176:179], a[172:175], v[120:123], v[176:179]
  v_mfma_f32_16x16x32_bf16 v[180:183], a[176:179], v[120:123], v[180:183]
  v_mfma_f32_16x16x32_bf16 v[184:187], a[180:183], v[120:123], v[184:187]
  v_mfma_f32_16x16x32_bf16 v[188:191], a[184:187], v[120:123], v[188:191]
  v_mfma_f32_16x16x32_bf16 v[192:195], a[188:191], v[120:123], v[192:195]
  s_waitcnt vmcnt(10) lgkmcnt(0)
  s_and_b32 s59, s94, 0xfe
  s_cmp_eq_u32 s59, 128
  s_waitcnt vmcnt(22)
  v_cmp_ne_u32 vcc, 0x01010101, v237
  s_nop 3
  s_cbranch_vccz L_full_ok_6
  s_mov_b32 s63, 20000
L_full_lp_7:
  buffer_load_dword v237, v236, s[28:31], 0 offen sc1
  s_waitcnt vmcnt(0)
  v_cmp_ne_u32 vcc, 0x01010101, v237
  s_nop 3
  s_cbranch_vccz L_full_ok_6
  s_sub_u32 s63, s63, 1
  s_cmp_lg_u32 s63, 0
  s_cbranch_scc1 L_full_lp_7
L_full_ok_6:
  ds_read_b64_tr_b16 a[130:131], v14 offset:28672
  ds_read_b64_tr_b16 a[134:135], v15 offset:28672
  ds_read_b64_tr_b16 a[138:139], v16 offset:28672
  ds_read_b64_tr_b16 a[142:143], v17 offset:28672
  ds_read_b64_tr_b16 a[146:147], v18 offset:28672
  ds_read_b64_tr_b16 a[150:151], v19 offset:28672
  ds_read_b64_tr_b16 a[154:155], v20 offset:28672
  ds_read_b64_tr_b16 a[158:159], v21 offset:28672
  s_mov_b32 s60, 0
  buffer_load_dwordx4 v[132:135], v80, s[24:27], s60 offen sc1
  s_mov_b32 s60, 4096
  buffer_load_dwordx4 v[136:139], v80, s[24:27], s60 offen sc1
  s_mov_b32 s60, 8192
  buffer_load_dwordx4 v[140:143], v80, s[24:27], s60 offen sc1
  s_mov_b32 s60, 12288
  buffer_load_dwordx4 v[144:147], v80, s[24:27], s60 offen sc1
  s_waitcnt vmcnt(10) lgkmcnt(0)
  ds_read_b64_tr_b16 a[160:161], v14 offset:0
  ds_read_b64_tr_b16 a[164:165], v15 offset:0
  ds_read_b64_tr_b16 a[168:169], v16 offset:0
  ds_read_b64_tr_b16 a[172:173], v17 offset:0
  ds_read_b64_tr_b16 a[176:177], v18 offset:0
  ds_read_b64_tr_b16 a[180:181], v19 offset:0
  ds_read_b64_tr_b16 a[184:185], v20 offset:0
  ds_read_b64_tr_b16 a[188:189], v21 offset:0
  v_mfma_f32_16x16x32_bf16 v[164:167], a[128:131], v[124:127], v[164:167]
  v_mfma_f32_16x16x32_bf16 v[168:171], a[132:135], v[124:127], v[168:171]
  v_mfma_f32_16x16x32_bf16 v[172:175], a[136:139], v[124:127], v[172:175]
  v_mfma_f32_16x16x32_bf16 v[176:179], a[140:143], v[124:127], v[176:179]
  v_mfma_f32_16x16x32_bf16 v[180:183], a[144:147], v[124:127], v[180:183]
  v_mfma_f32_16x16x32_bf16 v[184:187], a[148:151], v[124:127], v[184:187]
  v_mfma_f32_16x16x32_bf16 v[188:191], a[152:155], v[124:127], v[188:191]
  v_mfma_f32_16x16x32_bf16 v[192:195], a[156:159], v[124:127], v[192:195]
  s_waitcnt vmcnt(6) lgkmcnt(0)
  ds_read_b64_tr_b16 a[162:163], v14 offset:4096
  ds_read_b64_tr_b16 a[166:167], v15 offset:4096
  ds_read_b64_tr_b16 a[170:171], v16 offset:4096
  ds_read_b64_tr_b16 a[174:175], v17 offset:4096
  ds_read_b64_tr_b16 a[178:179], v18 offset:4096
  ds_read_b64_tr_b16 a[182:183], v19 offset:4096
  ds_read_b64_tr_b16 a[186:187], v20 offset:4096
  ds_read_b64_tr_b16 a[190:191], v21 offset:4096
  s_waitcnt lgkmcnt(0)
  v_mfma_f32_16x16x32_bf16 v[164:167], a[160:163], v[128:131], v[164:167]
  v_mfma_f32_16x16x32_bf16 v[168:171], a[164:167], v[128:131], v[168:171]
  v_mfma_f32_16x16x32_bf16 v[172:175], a[168:171], v[128:131], v[172:175]
  v_mfma_f32_16x16x32_bf16 v[176:179], a[172:175], v[128:131], v[176:179]
  v_mfma_f32_16x16x32_bf16 v[180:183], a[176:179], v[128:131], v[180:183]
  v_mfma_f32_16x16x32_bf16 v[184:187], a[180:183], v[128:131], v[184:187]
  v_mfma_f32_16x16x32_bf16 v[188:191], a[184:187], v[128:131], v[188:191]
  v_mfma_f32_16x16x32_bf16 v[192:195], a[188:191], v[128:131], v[192:195]
  s_mov_b32 exec_lo, 0x00ff00ff
  s_mov_b32 exec_hi, 0x00ff00ff
  ds_write_b128 v34, v[164:167] offset:0
  ds_write_b128 v34, v[168:171] offset:64
  ds_write_b128 v34, v[172:175] offset:128
  ds_write_b128 v34, v[176:179] offset:192
  ds_write_b128 v34, v[180:183] offset:256
  ds_write_b128 v34, v[184:187] offset:320
  ds_write_b128 v34, v[188:191] offset:384
  ds_write_b128 v34, v[192:195] offset:448
  s_mov_b64 exec, -1
  s_waitcnt lgkmcnt(0)
  s_barrier
  ds_read_b128 v[200:203], v35 offset:0
  ds_read_b128 v[204:207], v35 offset:4608
  ds_read_b128 v[208:211], v35 offset:9216
  ds_read_b128 v[212:215], v35 offset:13824
  s_waitcnt lgkmcnt(0)
  v_pk_add_f32 v[200:201], v[200:201], v[204:205]
  v_pk_add_f32 v[202:203], v[202:203], v[206:207]
  v_pk_add_f32 v[208:209], v[208:209], v[212:213]
  v_pk_add_f32 v[210:211], v[210:211], v[214:215]
  v_pk_add_f32 v[200:201], v[200:201], v[208:209]
  v_pk_add_f32 v[202:203], v[202:203], v[210:211]
  buffer_store_dwordx4 v[200:203], v27, s[24:27], 0 offen sc1
  s_cmp_lt_u32 s94, 128
  s_cbranch_scc1 L_h2
  s_bfe_u32 s59, s94, 0x40003
  s_lshl_b32 s60, s59, 2
  s_add_u32 s60, s60, s52
  s_lshl_b32 s60, s60, 11
  s_lshl_b32 s61, s95, 17
  s_add_u32 s60, s60, s61
  s_add_u32 s60, s60, 1048576
  v_lshl_add_u32 v196, v1, 5, s60
  s_lshr_b32 s59, s59, 1
  s_lshl_b32 s61, s95, 3
  s_add_u32 s59, s59, s61
  s_lshl_b32 s59, s59, 8
  s_add_u32 s59, s59, 2097152
  v_lshrrev_b32 v197, 1, v1
  v_lshl_add_u32 v197, v197, 3, s59
  s_mov_b32 s63, 20000
L_h1_poll_8:
  buffer_load_dwordx4 v[200:203], v196, s[24:27], 0 offen sc1
  buffer_load_dwordx4 v[204:207], v196, s[24:27], 0 offen offset:16 sc1
  buffer_load_dwordx2 v[208:209], v197, s[24:27], 0 offen sc1
  s_waitcnt vmcnt(0)
  v_max3_u32 v198, v200, v201, v202
  v_max3_u32 v198, v198, v203, v204
  v_max3_u32 v198, v198, v205, v206
  v_max3_u32 v198, v198, v207, v208
  v_max_u32 v198, v198, v209
  v_cmp_eq_u32 vcc, -1, v198
  s_mov_b64 exec, vcc
  s_nop 2
  s_cbranch_execz L_h1_poll_done_9
  s_sub_u32 s63, s63, 1
  s_cmp_lg_u32 s63, 0
  s_cbranch_scc1 L_h1_poll_8
L_h1_poll_done_9:
  s_mov_b64 exec, -1
  v_mov_b32 v210, v208
  s_nop 1
  v_max_f32_dpp v210, v210, v210 row_ror:2 row_mask:0xf bank_mask:0xf
  s_nop 1
  v_max_f32_dpp v210, v210, v210 row_ror:4 row_mask:0xf bank_mask:0xf
  s_nop 1
  v_max_f32_dpp v210, v210, v210 row_ror:8 row_mask:0xf bank_mask:0xf
  v_mov_b32 v211, v210
  s_nop 1
  v_permlane16_swap_b32 v210, v211
  v_max_f32 v210, v210, v211
  v_mov_b32 v211, v210
  s_nop 1
  v_permlane32_swap_b32 v210, v211
  v_max_f32 v210, v210, v211
  v_sub_f32 v211, v208, v210
  v_mul_f32 v211, 0x3fb8aa3b, v211
  v_exp_f32 v211, v211
  s_nop 0
  v_mul_f32 v212, v209, v211
  v_mul_f32 v200, v200, v211
  v_mul_f32 v201, v201, v211
  v_mul_f32 v202, v202, v211
  v_mul_f32 v203, v203, v211
  v_mul_f32 v204, v204, v211
  v_mul_f32 v205, v205, v211
  v_mul_f32 v206, v206, v211
  v_mul_f32 v207, v207, v211
  v_permlane32_swap_b32 v200, v204
  v_permlane32_swap_b32 v201, v205
  v_permlane32_swap_b32 v202, v206
  v_permlane32_swap_b32 v203, v207
  v_add_f32 v200, v200, v204
  v_add_f32 v201, v201, v205
  v_add_f32 v202, v202, v206
  v_add_f32 v203, v203, v207
  s_nop 0
  v_permlane16_swap_b32 v200, v202
  v_permlane16_swap_b32 v201, v203
  v_add_f32 v200, v200, v202
  v_add_f32 v201, v201, v203
  s_nop 0
  v_add_f32_dpp v200, v200, v200 row_ror:2 row_mask:0xf bank_mask:0xf
  v_add_f32_dpp v201, v201, v201 row_ror:2 row_mask:0xf bank_mask:0xf
  s_nop 0
  v_add_f32_dpp v200, v200, v200 row_ror:4 row_mask:0xf bank_mask:0xf
  v_add_f32_dpp v201, v201, v201 row_ror:4 row_mask:0xf bank_mask:0xf
  s_nop 0
  v_add_f32_dpp v200, v200, v200 row_ror:8 row_mask:0xf bank_mask:0xf
  v_add_f32_dpp v201, v201, v201 row_ror:8 row_mask:0xf bank_mask:0xf
  v_add_f32_dpp v212, v212, v212 row_ror:2 row_mask:0xf bank_mask:0xf
  s_nop 1
  v_add_f32_dpp v212, v212, v212 row_ror:4 row_mask:0xf bank_mask:0xf
  s_nop 1
  v_add_f32_dpp v212, v212, v212 row_ror:8 row_mask:0xf bank_mask:0xf
  v_mov_b32 v211, v212
  s_nop 1
  v_permlane16_swap_b32 v212, v211
  v_add_f32 v212, v212, v211
  v_mov_b32 v211, v212
  s_nop 1
  v_permlane32_swap_b32 v212, v211
  v_add_f32 v212, v212, v211
  v_rcp_f32 v211, v212
  s_nop 0
  v_mul_f32 v200, v200, v211
  v_mul_f32 v201, v201, v211
  v_cvt_pk_bf16_f32 v200, v200, v201
  buffer_store_dword v200, v29, s[24:27], 0 offen sc1
  s_and_b32 s59, s94, 0xfe
  s_cmp_eq_u32 s59, 128
  s_cbranch_scc1 L_fin
  s_branch L_exit
L_h2:
  s_add_u32 m0, s56, 8192
  s_add_u32 s3, s58, 0
  buffer_load_dwordx4 v9, s[16:19], s3 offen offset:0 nt lds
  s_add_u32 s3, s58, 15360
  buffer_load_dwordx4 v9, s[16:19], s3 offen offset:1024 nt lds
  s_add_u32 s3, s58, 30720
  buffer_load_dwordx4 v9, s[16:19], s3 offen offset:2048 nt lds
  s_add_u32 s3, s58, 46080
  buffer_load_dwordx4 v9, s[16:19], s3 offen offset:3072 nt lds
  s_add_u32 m0, s56, 12288
  s_add_u32 s3, s58, 65536
  buffer_load_dwordx4 v9, s[16:19], s3 offen offset:0 nt lds
  s_add_u32 s3, s58, 80896
  buffer_load_dwordx4 v9, s[16:19], s3 offen offset:1024 nt lds
  s_add_u32 s3, s58, 96256
  buffer_load_dwordx4 v9, s[16:19], s3 offen offset:2048 nt lds
  s_add_u32 s3, s58, 111616
  buffer_load_dwordx4 v9, s[16:19], s3 offen offset:3072 nt lds
  s_add_u32 m0, s56, 16384
  s_add_u32 s3, s58, 131072
  buffer_load_dwordx4 v9, s[16:19], s3 offen offset:0 nt lds
  s_add_u32 s3, s58, 146432
  buffer_load_dwordx4 v9, s[16:19], s3 offen offset:1024 nt lds
  s_add_u32 s3, s58, 161792
  buffer_load_dwordx4 v9, s[16:19], s3 offen offset:2048 nt lds
  s_add_u32 s3, s58, 177152
  buffer_load_dwordx4 v9, s[16:19], s3 offen offset:3072 nt lds
  s_add_u32 m0, s56, 20480
  s_add_u32 s3, s58, 196608
  buffer_load_dwordx4 v9, s[16:19], s3 offen offset:0 nt lds
  s_add_u32 s3, s58, 211968
  buffer_load_dwordx4 v9, s[16:19], s3 offen offset:1024 nt lds
  s_add_u32 s3, s58, 227328
  buffer_load_dwordx4 v9, s[16:19], s3 offen offset:2048 nt lds
  s_add_u32 s3, s58, 242688
  buffer_load_dwordx4 v9, s[16:19], s3 offen offset:3072 nt lds
  s_and_b32 s59, s95, 3
  s_lshl_b32 s59, s59, 1
  s_lshr_b32 s60, s95, 2
  s_add_u32 s59, s59, s60
  s_lshl_b32 s59, s59, 2
  s_add_u32 s59, s59, s52
  s_lshl_b32 s59, s59, 8
  s_add_u32 s59, s59, 2162688
  v_lshrrev_b32 v236, 5, v1
  v_lshlrev_b32 v236, 13, v236
  v_and_b32 v237, 31, v1
  v_lshl_add_u32 v236, v237, 3, v236
  v_add_u32 v236, s59, v236
  v_lshrrev_b32 v238, 5, v1
  v_lshlrev_b32 v238, 8, v238
  v_lshrrev_b32 v239, 3, v237
  v_lshl_or_b32 v238, v239, 6, v238
  v_and_b32 v239, 3, v237
  v_lshl_or_b32 v238, v239, 4, v238
  v_bfe_u32 v239, v237, 2, 1
  v_lshl_or_b32 v238, v239, 3, v238
  s_lshl_b32 s59, s52, 9
  s_add_u32 s59, s59, 136192
  v_add_u32 v238, s59, v238
  v_and_b32 v239, 1, v32
  v_lshlrev_b32 v239, 8, v239
  v_lshl_or_b32 v239, v33, 4, v239
  v_add_u32 v239, s59, v239
  v_lshlrev_b32 v196, 8, v32
  v_lshl_add_u32 v196, v33, 4, v196
  s_lshl_b32 s59, s52, 9
  s_add_u32 s59, s59, 131072
  v_add_u32 v196, s59, v196
  v_and_b32 v197, 7, v1
  v_lshlrev_b32 v197, 4, v197
  s_lshl_b32 s59, s52, 7
  s_add_u32 s59, s59, 131072
  v_add_u32 v197, s59, v197
  s_mov_b32 s62, 1
  s_branch L_h2_body
L_h2_real:
  s_waitcnt vmcnt(12)
  ds_read_b64_tr_b16 a[0:1], v22 offset:8192
  ds_read_b64_tr_b16 a[2:3], v22 offset:10240
  ds_read_b64_tr_b16 a[4:5], v23 offset:8192
  ds_read_b64_tr_b16 a[6:7], v23 offset:10240
  ds_read_b64_tr_b16 a[8:9], v24 offset:8192
  ds_read_b64_tr_b16 a[10:11], v24 offset:10240
  ds_read_b64_tr_b16 a[12:13], v25 offset:8192
  ds_read_b64_tr_b16 a[14:15], v25 offset:10240
  s_waitcnt vmcnt(8)
  ds_read_b64_tr_b16 a[16:17], v22 offset:12288
  ds_read_b64_tr_b16 a[18:19], v22 offset:14336
  ds_read_b64_tr_b16 a[20:21], v23 offset:12288
  ds_read_b64_tr_b16 a[22:23], v23 offset:14336
  ds_read_b64_tr_b16 a[24:25], v24 offset:12288
  ds_read_b64_tr_b16 a[26:27], v24 offset:14336
  ds_read_b64_tr_b16 a[28:29], v25 offset:12288
  ds_read_b64_tr_b16 a[30:31], v25 offset:14336
  s_waitcnt vmcnt(4)
  ds_read_b64_tr_b16 a[32:33], v22 offset:16384
  ds_read_b64_tr_b16 a[34:35], v22 offset:18432
  ds_read_b64_tr_b16 a[36:37], v23 offset:16384
  ds_read_b64_tr_b16 a[38:39], v23 offset:18432
  ds_read_b64_tr_b16 a[40:41], v24 offset:16384
  ds_read_b64_tr_b16 a[42:43], v24 offset:18432
  ds_read_b64_tr_b16 a[44:45], v25 offset:16384
  ds_read_b64_tr_b16 a[46:47], v25 offset:18432
  s_waitcnt vmcnt(0)
  ds_read_b64_tr_b16 a[48:49], v22 offset:20480
  ds_read_b64_tr_b16 a[50:51], v22 offset:22528
  ds_read_b64_tr_b16 a[52:53], v23 offset:20480
  ds_read_b64_tr_b16 a[54:55], v23 offset:22528
  ds_read_b64_tr_b16 a[56:57], v24 offset:20480
  ds_read_b64_tr_b16 a[58:59], v24 offset:22528
  ds_read_b64_tr_b16 a[60:61], v25 offset:20480
  ds_read_b64_tr_b16 a[62:63], v25 offset:22528
  s_mov_b32 s63, 20000
L_h2_poll_10:
  buffer_load_dwordx2 v[240:241], v236, s[24:27], 0 offen sc1
  s_waitcnt vmcnt(0)
  v_max_u32 v198, v240, v241
  v_cmp_eq_u32 vcc, -1, v198
  s_mov_b64 exec, vcc
  s_nop 2
  s_cbranch_execz L_h2_poll_done_11
  s_sub_u32 s63, s63, 1
  s_cmp_lg_u32 s63, 0
  s_cbranch_scc1 L_h2_poll_10
L_h2_poll_done_11:
  s_mov_b64 exec, -1
L_h2_body:
  ds_write_b64 v238, v[240:241]
  s_waitcnt lgkmcnt(0)
  ds_read_b128 v[100:103], v239 offset:0
  ds_read_b128 v[104:107], v239 offset:64
  ds_read_b128 v[108:111], v239 offset:128
  ds_read_b128 v[112:115], v239 offset:192
  s_waitcnt lgkmcnt(3)
  v_mfma_f32_16x16x32_bf16 v[148:151], a[0:3], v[100:103], 0
  v_mfma_f32_16x16x32_bf16 v[152:155], a[4:7], v[100:103], 0
  v_mfma_f32_16x16x32_bf16 v[156:159], a[8:11], v[100:103], 0
  v_mfma_f32_16x16x32_bf16 v[160:163], a[12:15], v[100:103], 0
  s_waitcnt lgkmcnt(2)
  v_mfma_f32_16x16x32_bf16 v[148:151], a[16:19], v[104:107], v[148:151]
  v_mfma_f32_16x16x32_bf16 v[152:155], a[20:23], v[104:107], v[152:155]
  v_mfma_f32_16x16x32_bf16 v[156:159], a[24:27], v[104:107], v[156:159]
  v_mfma_f32_16x16x32_bf16 v[160:163], a[28:31], v[104:107], v[160:163]
  s_waitcnt lgkmcnt(1)
  v_mfma_f32_16x16x32_bf16 v[148:151], a[32:35], v[108:111], v[148:151]
  v_mfma_f32_16x16x32_bf16 v[152:155], a[36:39], v[108:111], v[152:155]
  v_mfma_f32_16x16x32_bf16 v[156:159], a[40:43], v[108:111], v[156:159]
  v_mfma_f32_16x16x32_bf16 v[160:163], a[44:47], v[108:111], v[160:163]
  s_waitcnt lgkmcnt(0)
  v_mfma_f32_16x16x32_bf16 v[148:151], a[48:51], v[112:115], v[148:151]
  v_mfma_f32_16x16x32_bf16 v[152:155], a[52:55], v[112:115], v[152:155]
  v_mfma_f32_16x16x32_bf16 v[156:159], a[56:59], v[112:115], v[156:159]
  v_mfma_f32_16x16x32_bf16 v[160:163], a[60:63], v[112:115], v[160:163]
  s_mov_b32 exec_lo, 0x00030003
  s_mov_b32 exec_hi, 0x00030003
  s_nop 2
  ds_write_b128 v196, v[148:151] offset:0
  ds_write_b128 v196, v[152:155] offset:64
  ds_write_b128 v196, v[156:159] offset:128
  ds_write_b128 v196, v[160:163] offset:192
  s_mov_b64 exec, -1
  s_waitcnt lgkmcnt(0)
  s_barrier
  ds_read_b128 v[200:203], v197 offset:0
  ds_read_b128 v[204:207], v197 offset:512
  ds_read_b128 v[208:211], v197 offset:1024
  ds_read_b128 v[212:215], v197 offset:1536
  s_waitcnt lgkmcnt(0)
  v_pk_add_f32 v[200:201], v[200:201], v[204:205]
  v_pk_add_f32 v[202:203], v[202:203], v[206:207]
  v_pk_add_f32 v[208:209], v[208:209], v[212:213]
  v_pk_add_f32 v[210:211], v[210:211], v[214:215]
  v_pk_add_f32 v[220:221], v[200:201], v[208:209]
  v_pk_add_f32 v[222:223], v[202:203], v[210:211]
  s_cmp_lg_u32 s62, 0
  s_mov_b32 s62, 0
  s_cbranch_scc1 L_h2_real
  buffer_store_dwordx4 v[220:223], v30, s[24:27], 0 offen sc1
  s_nop 0
  s_branch L_exit
L_fin:
  s_and_b32 s62, s94, 1
  s_lshl_b32 s59, s62, 11
  v_lshl_add_u32 v236, v0, 3, s59
  buffer_load_dwordx2 v[238:239], v236, s[20:23], 0 offen
  v_lshlrev_b32 v237, 4, v0
  v_max3_u32 v198, v132, v133, v134
  v_max3_u32 v198, v198, v135, v136
  v_max3_u32 v198, v198, v137, v138
  v_max3_u32 v198, v198, v139, v140
  v_max3_u32 v198, v198, v141, v142
  v_max3_u32 v198, v198, v143, v144
  v_max3_u32 v198, v198, v145, v146
  v_max_u32 v198, v198, v147
  v_cmp_eq_u32 vcc, -1, v198
  s_nop 3
  s_cbranch_vccz L_tb_ok_12
  s_mov_b32 s63, 20000
L_tb_poll_13:
  s_mov_b32 s60, 0
  buffer_load_dwordx4 v[132:135], v80, s[24:27], s60 offen sc1
  s_mov_b32 s60, 4096
  buffer_load_dwordx4 v[136:139], v80, s[24:27], s60 offen sc1
  s_mov_b32 s60, 8192
  buffer_load_dwordx4 v[140:143], v80, s[24:27], s60 offen sc1
  s_mov_b32 s60, 12288
  buffer_load_dwordx4 v[144:147], v80, s[24:27], s60 offen sc1
  s_waitcnt vmcnt(0)
  v_max3_u32 v198, v132, v133, v134
  v_max3_u32 v198, v198, v135, v136
  v_max3_u32 v198, v198, v137, v138
  v_max3_u32 v198, v198, v139, v140
  v_max3_u32 v198, v198, v141, v142
  v_max3_u32 v198, v198, v143, v144
  v_max3_u32 v198, v198, v145, v146
  v_max_u32 v198, v198, v147
  v_cmp_eq_u32 vcc, -1, v198
  s_mov_b64 exec, vcc
  s_nop 2
  s_cbranch_execz L_tb_poll_done_14
  s_sub_u32 s63, s63, 1
  s_cmp_lg_u32 s63, 0
  s_cbranch_scc1 L_tb_poll_13
L_tb_poll_done_14:
  s_mov_b64 exec, -1
L_tb_ok_12:
  s_barrier
  ds_write_b128 v237, v[132:135] offset:0
  ds_write_b128 v237, v[136:139] offset:4096
  ds_write_b128 v237, v[140:143] offset:8192
  ds_write_b128 v237, v[144:147] offset:12288
  v_mov_b32 v196, 140416
  v_mov_b32 v197, 0
  ds_write_b32 v196, v197
  s_lshl_b32 s59, s62, 15
  s_add_u32 s59, s59, 2228224
  v_add_u32 v240, s59, v237
  s_mov_b32 s62, 1
  s_branch L_fin_body
L_fin_real:
  s_mov_b32 s63, 20000
L_ap_poll_15:
  s_mov_b32 s60, 0
  buffer_load_dwordx4 v[100:103], v240, s[24:27], s60 offen sc1
  s_mov_b32 s60, 4096
  buffer_load_dwordx4 v[104:107], v240, s[24:27], s60 offen sc1
  s_mov_b32 s60, 8192
  buffer_load_dwordx4 v[108:111], v240, s[24:27], s60 offen sc1
  s_mov_b32 s60, 12288
  buffer_load_dwordx4 v[112:115], v240, s[24:27], s60 offen sc1
  s_mov_b32 s60, 16384
  buffer_load_dwordx4 v[116:119], v240, s[24:27], s60 offen sc1
  s_mov_b32 s60, 20480
  buffer_load_dwordx4 v[120:123], v240, s[24:27], s60 offen sc1
  s_mov_b32 s60, 24576
  buffer_load_dwordx4 v[124:127], v240, s[24:27], s60 offen sc1
  s_mov_b32 s60, 28672
  buffer_load_dwordx4 v[128:131], v240, s[24:27], s60 offen sc1
  s_waitcnt vmcnt(0)
  v_max3_u32 v198, v100, v101, v102
  v_max3_u32 v198, v198, v103, v104
  v_max3_u32 v198, v198, v105, v106
  v_max3_u32 v198, v198, v107, v108
  v_max3_u32 v198, v198, v109, v110
  v_max3_u32 v198, v198, v111, v112
  v_max3_u32 v198, v198, v113, v114
  v_max3_u32 v198, v198, v115, v116
  v_max3_u32 v198, v198, v117, v118
  v_max3_u32 v198, v198, v119, v120
  v_max3_u32 v198, v198, v121, v122
  v_max3_u32 v198, v198, v123, v124
  v_max3_u32 v198, v198, v125, v126
  v_max3_u32 v198, v198, v127, v128
  v_max3_u32 v198, v198, v129, v130
  v_max_u32 v198, v198, v131
  v_cmp_eq_u32 vcc, -1, v198
  s_mov_b64 exec, vcc
  s_nop 2
  s_cbranch_execz L_ap_poll_done_16
  s_sub_u32 s63, s63, 1
  s_cmp_lg_u32 s63, 0
  s_cbranch_scc1 L_ap_poll_15
L_ap_poll_done_16:
  s_mov_b64 exec, -1
L_fin_body:
  v_pk_add_f32 v[100:101], v[100:101], v[116:117]
  v_pk_add_f32 v[102:103], v[102:103], v[118:119]
  v_pk_add_f32 v[104:105], v[104:105], v[120:121]
  v_pk_add_f32 v[106:107], v[106:107], v[122:123]
  v_pk_add_f32 v[108:109], v[108:109], v[124:125]
  v_pk_add_f32 v[110:111], v[110:111], v[126:127]
  v_pk_add_f32 v[112:113], v[112:113], v[128:129]
  v_pk_add_f32 v[114:115], v[114:115], v[130:131]
  v_pk_add_f32 v[100:101], v[100:101], v[108:109]
  v_pk_add_f32 v[102:103], v[102:103], v[110:111]
  v_pk_add_f32 v[104:105], v[104:105], v[112:113]
  v_pk_add_f32 v[106:107], v[106:107], v[114:115]
  v_pk_add_f32 v[100:101], v[100:101], v[104:105]
  v_pk_add_f32 v[102:103], v[102:103], v[106:107]
  v_lshlrev_b32 v136, 16, v238
  v_and_b32 v137, 0xffff0000, v238
  v_lshlrev_b32 v138, 16, v239
  v_and_b32 v139, 0xffff0000, v239
  v_cvt_pk_bf16_f32 v100, 0, v100
  v_cvt_pk_bf16_f32 v101, 0, v101
  v_cvt_pk_bf16_f32 v102, 0, v102
  v_cvt_pk_bf16_f32 v103, 0, v103
  v_pk_add_f32 v[132:133], v[100:101], v[136:137]
  v_pk_add_f32 v[134:135], v[102:103], v[138:139]
  v_cvt_pk_bf16_f32 v132, 0, v132
  v_cvt_pk_bf16_f32 v133, 0, v133
  v_cvt_pk_bf16_f32 v134, 0, v134
  v_cvt_pk_bf16_f32 v135, 0, v135
  v_add_f32 v196, v132, v133
  v_add_f32 v198, v134, v135
  v_add_f32 v196, v196, v198
  s_nop 1
  v_add_f32_dpp v196, v196, v196 row_ror:8 row_mask:0xf bank_mask:0xf
  s_nop 1
  v_add_f32_dpp v196, v196, v196 row_ror:4 row_mask:0xf bank_mask:0xf
  s_nop 1
  v_add_f32_dpp v196, v196, v196 row_ror:2 row_mask:0xf bank_mask:0xf
  s_nop 1
  v_add_f32_dpp v196, v196, v196 row_ror:1 row_mask:0xf bank_mask:0xf
  v_mov_b32 v198, v196
  s_nop 1
  v_permlane16_swap_b32 v196, v198
  v_add_f32 v196, v196, v198
  v_mov_b32 v198, v196
  s_nop 1
  v_permlane32_swap_b32 v196, v198
  v_add_f32 v196, v196, v198
  v_mul_f32 v196, 0x3b800000, v196
  v_sub_f32 v140, v132, v196
  v_sub_f32 v141, v133, v196
  v_sub_f32 v142, v134, v196
  v_sub_f32 v143, v135, v196
  v_mul_f32 v197, v140, v140
  v_fmac_f32 v197, v141, v141
  v_fmac_f32 v197, v142, v142
  v_fmac_f32 v197, v143, v143
  s_nop 1
  v_add_f32_dpp v197, v197, v197 row_ror:8 row_mask:0xf bank_mask:0xf
  s_nop 1
  v_add_f32_dpp v197, v197, v197 row_ror:4 row_mask:0xf bank_mask:0xf
  s_nop 1
  v_add_f32_dpp v197, v197, v197 row_ror:2 row_mask:0xf bank_mask:0xf
  s_nop 1
  v_add_f32_dpp v197, v197, v197 row_ror:1 row_mask:0xf bank_mask:0xf
  v_mov_b32 v198, v197
  s_nop 1
  v_permlane16_swap_b32 v197, v198
  v_add_f32 v197, v197, v198
  v_mov_b32 v198, v197
  s_nop 1
  v_permlane32_swap_b32 v197, v198
  v_add_f32 v197, v197, v198
  s_lshl_b32 s59, s52, 3
  s_add_u32 s59, s59, 140288
  v_mov_b32 v198, s59
  ds_write_b64 v198, v[196:197]
  s_waitcnt lgkmcnt(0)
  s_barrier
  v_mov_b32 v198, 140288
  ds_read_b128 v[200:203], v198
  ds_read_b128 v[204:207], v198 offset:16
  s_waitcnt lgkmcnt(0)
  v_add_f32 v208, v200, v202
  v_add_f32 v198, v204, v206
  v_add_f32 v208, v208, v198
  v_mul_f32 v208, 0x3e800000, v208
  v_add_f32 v209, v201, v203
  v_add_f32 v198, v205, v207
  v_add_f32 v209, v209, v198
  v_sub_f32 v200, v200, v208
  v_sub_f32 v202, v202, v208
  v_sub_f32 v204, v204, v208
  v_sub_f32 v206, v206, v208
  v_mul_f32 v198, v200, v200
  v_fmac_f32 v198, v202, v202
  v_fmac_f32 v198, v204, v204
  v_fmac_f32 v198, v206, v206
  v_fmamk_f32 v209, v198, 0x43800000, v209
  v_mul_f32 v209, 0x3a800000, v209
  v_cvt_pk_bf16_f32 v208, 0, v208
  v_cvt_pk_bf16_f32 v209, 0, v209
  v_add_f32 v209, 0x3727c5ac, v209
  v_cvt_pk_bf16_f32 v209, 0, v209
  v_sqrt_f32 v209, v209
  s_nop 0
  v_cvt_pk_bf16_f32 v209, 0, v209
  v_rcp_f32 v209, v209
  v_sub_f32 v144, v132, v208
  v_sub_f32 v145, v133, v208
  v_sub_f32 v146, v134, v208
  v_sub_f32 v147, v135, v208
  v_cvt_pk_bf16_f32 v144, 0, v144
  v_cvt_pk_bf16_f32 v145, 0, v145
  v_cvt_pk_bf16_f32 v146, 0, v146
  v_cvt_pk_bf16_f32 v147, 0, v147
  v_mul_f32 v144, v144, v209
  v_mul_f32 v145, v145, v209
  v_mul_f32 v146, v146, v209
  v_mul_f32 v147, v147, v209
  v_cvt_pk_bf16_f32 v144, 0, v144
  v_cvt_pk_bf16_f32 v145, 0, v145
  v_cvt_pk_bf16_f32 v146, 0, v146
  v_cvt_pk_bf16_f32 v147, 0, v147
  v_add_f32 v196, v144, v145
  v_add_f32 v198, v146, v147
  v_mul_f32 v197, v144, v144
  v_add_f32 v196, v196, v198
  v_fmac_f32 v197, v145, v145
  v_fmac_f32 v197, v146, v146
  v_fmac_f32 v197, v147, v147
  v_add_f32_dpp v196, v196, v196 row_ror:8 row_mask:0xf bank_mask:0xf
  s_nop 0
  v_add_f32_dpp v197, v197, v197 row_ror:8 row_mask:0xf bank_mask:0xf
  v_add_f32_dpp v196, v196, v196 row_ror:4 row_mask:0xf bank_mask:0xf
  s_nop 0
  v_add_f32_dpp v197, v197, v197 row_ror:4 row_mask:0xf bank_mask:0xf
  v_add_f32_dpp v196, v196, v196 row_ror:2 row_mask:0xf bank_mask:0xf
  s_nop 0
  v_add_f32_dpp v197, v197, v197 row_ror:2 row_mask:0xf bank_mask:0xf
  v_add_f32_dpp v196, v196, v196 row_ror:1 row_mask:0xf bank_mask:0xf
  s_nop 0
  v_add_f32_dpp v197, v197, v197 row_ror:1 row_mask:0xf bank_mask:0xf
  v_mov_b32 v198, v196
  v_mov_b32 v199, v197
  s_nop 0
  v_permlane16_swap_b32 v196, v198
  v_permlane16_swap_b32 v197, v199
  v_add_f32 v196, v196, v198
  v_add_f32 v197, v197, v199
  v_mov_b32 v198, v196
  v_mov_b32 v199, v197
  s_nop 0
  v_permlane32_swap_b32 v196, v198
  v_permlane32_swap_b32 v197, v199
  v_add_f32 v196, v196, v198
  v_add_f32 v197, v197, v199
  s_add_u32 s59, s59, 32
  v_mov_b32 v198, s59
  ds_write_b64 v198, v[196:197]
  s_waitcnt lgkmcnt(0)
  s_barrier
  v_mov_b32 v198, 140320
  ds_read_b128 v[200:203], v198
  ds_read_b128 v[204:207], v198 offset:16
  s_waitcnt lgkmcnt(0)
  v_add_f32 v208, v200, v202
  v_add_f32 v198, v204, v206
  v_add_f32 v209, v201, v203
  v_add_f32 v199, v205, v207
  v_add_f32 v208, v208, v198
  v_add_f32 v209, v209, v199
  v_mul_f32 v208, 0x3a800000, v208
  v_mul_f32 v209, 0x3a800000, v209
  v_fma_f32 v209, -v208, v208, v209
  v_max_f32 v209, 0, v209
  v_cvt_pk_bf16_f32 v208, 0, v208
  v_cvt_pk_bf16_f32 v209, 0, v209
  v_add_f32 v209, 0x3727c5ac, v209
  v_cvt_pk_bf16_f32 v209, 0, v209
  v_sqrt_f32 v209, v209
  s_nop 0
  v_cvt_pk_bf16_f32 v209, 0, v209
  v_rcp_f32 v209, v209
  v_sub_f32 v148, v144, v208
  v_sub_f32 v149, v145, v208
  v_sub_f32 v150, v146, v208
  v_sub_f32 v151, v147, v208
  v_cvt_pk_bf16_f32 v148, 0, v148
  v_cvt_pk_bf16_f32 v149, 0, v149
  v_cvt_pk_bf16_f32 v150, 0, v150
  v_cvt_pk_bf16_f32 v151, 0, v151
  v_mul_f32 v148, v148, v209
  v_mul_f32 v149, v149, v209
  v_mul_f32 v150, v150, v209
  v_mul_f32 v151, v151, v209
  v_cvt_pk_bf16_f32 v148, 0, v148
  v_cvt_pk_bf16_f32 v149, 0, v149
  v_cvt_pk_bf16_f32 v150, 0, v150
  v_cvt_pk_bf16_f32 v151, 0, v151
  v_bfe_u32 v200, v148, 16, 15
  v_bfe_u32 v201, v149, 16, 15
  v_bfe_u32 v202, v150, 16, 15
  v_bfe_u32 v203, v151, 16, 15
  v_subrev_u32 v200, 14592, v200
  v_subrev_u32 v201, 14592, v201
  v_subrev_u32 v202, 14592, v202
  v_subrev_u32 v203, 14592, v203
  v_max_u32 v204, v200, v201
  v_max3_u32 v204, v204, v202, v203
  v_cmp_lt_u32 vcc, 2047, v204
  s_mov_b64 s[98:99], vcc
  v_min_u32 v208, 2047, v200
  v_lshrrev_b32 v212, 31, v148
  v_min_u32 v209, 2047, v201
  v_lshrrev_b32 v213, 31, v149
  v_min_u32 v210, 2047, v202
  v_lshrrev_b32 v214, 31, v150
  v_min_u32 v211, 2047, v203
  v_lshrrev_b32 v215, 31, v151
  v_lshl_or_b32 v208, v212, 11, v208
  v_lshl_or_b32 v209, v213, 11, v209
  v_lshl_or_b32 v210, v214, 11, v210
  v_lshl_or_b32 v211, v215, 11, v211
  v_lshlrev_b32 v208, 2, v208
  v_lshlrev_b32 v209, 2, v209
  v_lshlrev_b32 v210, 2, v210
  v_lshlrev_b32 v211, 2, v211
  ds_read_b32 v140, v208 offset:0
  ds_read_b32 v141, v209 offset:0
  ds_read_b32 v142, v210 offset:0
  ds_read_b32 v143, v211 offset:0
  s_waitcnt lgkmcnt(0)
  v_add_f32 v140, v140, v132
  v_add_f32 v141, v141, v133
  v_add_f32 v142, v142, v134
  v_add_f32 v143, v143, v135
  v_cvt_pk_bf16_f32 v216, v140, v141
  v_cvt_pk_bf16_f32 v217, v142, v143
  s_cmp_lg_u32 s62, 0
  s_mov_b32 s62, 0
  s_cbranch_scc1 L_fin_real
  buffer_store_dwordx2 v[216:217], v236, s[32:35], 0 offen
  s_cmp_eq_u64 s[98:99], 0
  s_cbranch_scc1 L_fb_skip_17
  v_cmp_lt_u32 vcc, 2047, v200
  s_and_saveexec_b64 s[98:99], vcc
  s_nop 2
  s_cbranch_execz L_fb_nx_18
  v_mov_b32 v196, 140416
  v_mov_b32 v197, 1
  ds_add_rtn_u32 v197, v196, v197
  s_waitcnt lgkmcnt(0)
  v_lshlrev_b32 v197, 4, v197
  v_mov_b32 v220, v148
  v_mov_b32 v221, v132
  v_add_u32 v222, 0, v236
  v_mov_b32 v223, 0
  ds_write_b128 v197, v[220:223] offset:16384
L_fb_nx_18:
  s_mov_b64 exec, -1
  v_cmp_lt_u32 vcc, 2047, v201
  s_and_saveexec_b64 s[98:99], vcc
  s_nop 2
  s_cbranch_execz L_fb_nx_19
  v_mov_b32 v196, 140416
  v_mov_b32 v197, 1
  ds_add_rtn_u32 v197, v196, v197
  s_waitcnt lgkmcnt(0)
  v_lshlrev_b32 v197, 4, v197
  v_mov_b32 v220, v149
  v_mov_b32 v221, v133
  v_add_u32 v222, 2, v236
  v_mov_b32 v223, 0
  ds_write_b128 v197, v[220:223] offset:16384
L_fb_nx_19:
  s_mov_b64 exec, -1
  v_cmp_lt_u32 vcc, 2047, v202
  s_and_saveexec_b64 s[98:99], vcc
  s_nop 2
  s_cbranch_execz L_fb_nx_20
  v_mov_b32 v196, 140416
  v_mov_b32 v197, 1
  ds_add_rtn_u32 v197, v196, v197
  s_waitcnt lgkmcnt(0)
  v_lshlrev_b32 v197, 4, v197
  v_mov_b32 v220, v150
  v_mov_b32 v221, v134
  v_add_u32 v222, 4, v236
  v_mov_b32 v223, 0
  ds_write_b128 v197, v[220:223] offset:16384
L_fb_nx_20:
  s_mov_b64 exec, -1
  v_cmp_lt_u32 vcc, 2047, v203
  s_and_saveexec_b64 s[98:99], vcc
  s_nop 2
  s_cbranch_execz L_fb_nx_21
  v_mov_b32 v196, 140416
  v_mov_b32 v197, 1
  ds_add_rtn_u32 v197, v196, v197
  s_waitcnt lgkmcnt(0)
  v_lshlrev_b32 v197, 4, v197
  v_mov_b32 v220, v151
  v_mov_b32 v221, v135
  v_add_u32 v222, 6, v236
  v_mov_b32 v223, 0
  ds_write_b128 v197, v[220:223] offset:16384
L_fb_nx_21:
  s_mov_b64 exec, -1
L_fb_skip_17:
  s_waitcnt vmcnt(0) lgkmcnt(0)
  s_barrier
  v_mov_b32 v196, 140416
  ds_read_b32 v197, v196
  s_waitcnt lgkmcnt(0)
  v_readfirstlane_b32 s61, v197
  s_cmp_eq_u32 s61, 0
  s_nop 2
  s_cbranch_scc1 L_exit
  s_mov_b32 s62, 0
L_fb_lp_22:
  s_lshl_b32 s59, s62, 4
  v_mov_b32 v238, s59
  ds_read_b128 v[240:243], v238 offset:16384
  v_mov_b32 v244, 0
  s_waitcnt lgkmcnt(0)
  v_readfirstlane_b32 s96, v240
  s_nop 1
  v_pk_mul_f32 v[224:225], s[96:97], v[40:41] op_sel_hi:[0,1]
  v_pk_mul_f32 v[226:227], s[96:97], v[42:43] op_sel_hi:[0,1]
  v_pk_mul_f32 v[228:229], s[96:97], v[44:45] op_sel_hi:[0,1]
  v_pk_mul_f32 v[230:231], s[96:97], v[46:47] op_sel_hi:[0,1]
  v_pk_mul_f32 v[232:233], s[96:97], v[48:49] op_sel_hi:[0,1]
  v_pk_mul_f32 v[234:235], s[96:97], v[50:51] op_sel_hi:[0,1]
  v_pk_mul_f32 v[236:237], s[96:97], v[52:53] op_sel_hi:[0,1]
  v_cvt_pk_bf16_f32 v224, 0, v224
  v_cvt_pk_bf16_f32 v225, 0, v225
  v_cvt_pk_bf16_f32 v226, 0, v226
  v_cvt_pk_bf16_f32 v227, 0, v227
  v_cvt_pk_bf16_f32 v228, 0, v228
  v_cvt_pk_bf16_f32 v229, 0, v229
  v_cvt_pk_bf16_f32 v230, 0, v230
  v_cvt_pk_bf16_f32 v231, 0, v231
  v_cvt_pk_bf16_f32 v232, 0, v232
  v_cvt_pk_bf16_f32 v233, 0, v233
  v_cvt_pk_bf16_f32 v234, 0, v234
  v_cvt_pk_bf16_f32 v235, 0, v235
  v_cvt_pk_bf16_f32 v236, 0, v236
  v_cvt_pk_bf16_f32 v237, 0, v237
  v_pk_add_f32 v[196:197], v[54:55], v[224:225]
  v_pk_add_f32 v[198:199], v[56:57], v[226:227]
  v_pk_add_f32 v[200:201], v[58:59], v[228:229]
  v_pk_add_f32 v[202:203], v[60:61], v[230:231]
  v_pk_add_f32 v[204:205], v[62:63], v[232:233]
  v_pk_add_f32 v[206:207], v[64:65], v[234:235]
  v_pk_add_f32 v[208:209], v[66:67], v[236:237]
  v_cvt_pk_bf16_f32 v196, 0, v196
  v_cvt_pk_bf16_f32 v197, 0, v197
  v_cvt_pk_bf16_f32 v198, 0, v198
  v_cvt_pk_bf16_f32 v199, 0, v199
  v_cvt_pk_bf16_f32 v200, 0, v200
  v_cvt_pk_bf16_f32 v201, 0, v201
  v_cvt_pk_bf16_f32 v202, 0, v202
  v_cvt_pk_bf16_f32 v203, 0, v203
  v_cvt_pk_bf16_f32 v204, 0, v204
  v_cvt_pk_bf16_f32 v205, 0, v205
  v_cvt_pk_bf16_f32 v206, 0, v206
  v_cvt_pk_bf16_f32 v207, 0, v207
  v_cvt_pk_bf16_f32 v208, 0, v208
  v_cvt_pk_bf16_f32 v209, 0, v209
  v_pk_mul_f32 v[210:211], v[196:197], v[196:197]
  v_pk_mul_f32 v[212:213], v[198:199], v[198:199]
  v_pk_mul_f32 v[214:215], v[200:201], v[200:201]
  v_pk_mul_f32 v[216:217], v[202:203], v[202:203]
  v_pk_mul_f32 v[218:219], v[204:205], v[204:205]
  v_pk_mul_f32 v[220:221], v[206:207], v[206:207]
  v_pk_mul_f32 v[222:223], v[208:209], v[208:209]
  v_pk_fma_f32 v[210:211], v[210:211], s[100:101], v[36:37] op_sel_hi:[1,0,1]
  v_pk_fma_f32 v[212:213], v[212:213], s[100:101], v[36:37] op_sel_hi:[1,0,1]
  v_pk_fma_f32 v[214:215], v[214:215], s[100:101], v[36:37] op_sel_hi:[1,0,1]
  v_pk_fma_f32 v[216:217], v[216:217], s[100:101], v[36:37] op_sel_hi:[1,0,1]
  v_pk_fma_f32 v[218:219], v[218:219], s[100:101], v[36:37] op_sel_hi:[1,0,1]
  v_pk_fma_f32 v[220:221], v[220:221], s[100:101], v[36:37] op_sel_hi:[1,0,1]
  v_pk_fma_f32 v[222:223], v[222:223], s[100:101], v[36:37] op_sel_hi:[1,0,1]
  v_pk_mul_f32 v[210:211], v[210:211], v[196:197]
  v_pk_mul_f32 v[212:213], v[212:213], v[198:199]
  v_pk_mul_f32 v[214:215], v[214:215], v[200:201]
  v_pk_mul_f32 v[216:217], v[216:217], v[202:203]
  v_pk_mul_f32 v[218:219], v[218:219], v[204:205]
  v_pk_mul_f32 v[220:221], v[220:221], v[206:207]
  v_pk_mul_f32 v[222:223], v[222:223], v[208:209]
  v_exp_f32 v210, v210
  v_exp_f32 v211, v211
  v_exp_f32 v212, v212
  v_exp_f32 v213, v213
  v_exp_f32 v214, v214
  v_exp_f32 v215, v215
  v_exp_f32 v216, v216
  v_exp_f32 v217, v217
  v_exp_f32 v218, v218
  v_exp_f32 v219, v219
  v_exp_f32 v220, v220
  v_exp_f32 v221, v221
  v_exp_f32 v222, v222
  v_exp_f32 v223, v223
  v_pk_add_f32 v[210:211], v[210:211], v[38:39]
  v_pk_add_f32 v[212:213], v[212:213], v[38:39]
  v_pk_add_f32 v[214:215], v[214:215], v[38:39]
  v_pk_add_f32 v[216:217], v[216:217], v[38:39]
  v_pk_add_f32 v[218:219], v[218:219], v[38:39]
  v_pk_add_f32 v[220:221], v[220:221], v[38:39]
  v_pk_add_f32 v[222:223], v[222:223], v[38:39]
  v_rcp_f32 v210, v210
  v_rcp_f32 v211, v211
  v_rcp_f32 v212, v212
  v_rcp_f32 v213, v213
  v_rcp_f32 v214, v214
  v_rcp_f32 v215, v215
  v_rcp_f32 v216, v216
  v_rcp_f32 v217, v217
  v_rcp_f32 v218, v218
  v_rcp_f32 v219, v219
  v_rcp_f32 v220, v220
  v_rcp_f32 v221, v221
  v_rcp_f32 v222, v222
  v_rcp_f32 v223, v223
  v_pk_mul_f32 v[210:211], v[210:211], v[196:197]
  v_pk_mul_f32 v[212:213], v[212:213], v[198:199]
  v_pk_mul_f32 v[214:215], v[214:215], v[200:201]
  v_pk_mul_f32 v[216:217], v[216:217], v[202:203]
  v_pk_mul_f32 v[218:219], v[218:219], v[204:205]
  v_pk_mul_f32 v[220:221], v[220:221], v[206:207]
  v_pk_mul_f32 v[222:223], v[222:223], v[208:209]
  v_cvt_pk_bf16_f32 v196, v210, v211
  v_cvt_pk_bf16_f32 v197, v212, v213
  v_cvt_pk_bf16_f32 v198, v214, v215
  v_cvt_pk_bf16_f32 v199, v216, v217
  v_cvt_pk_bf16_f32 v200, v218, v219
  v_cvt_pk_bf16_f32 v201, v220, v221
  v_cvt_pk_bf16_f32 v202, v222, v223
  v_dot2c_f32_bf16 v244, v196, v68
  v_dot2c_f32_bf16 v244, v197, v69
  v_dot2c_f32_bf16 v244, v198, v70
  v_dot2c_f32_bf16 v244, v199, v71
  v_dot2c_f32_bf16 v244, v200, v72
  v_dot2c_f32_bf16 v244, v201, v73
  v_dot2c_f32_bf16 v244, v202, v74
  s_nop 2
  v_add_f32_dpp v244, v244, v244 row_ror:8 row_mask:0xf bank_mask:0xf
  s_nop 1
  v_add_f32_dpp v244, v244, v244 row_ror:4 row_mask:0xf bank_mask:0xf
  s_nop 1
  v_add_f32_dpp v244, v244, v244 row_ror:2 row_mask:0xf bank_mask:0xf
  s_nop 1
  v_add_f32_dpp v244, v244, v244 row_ror:1 row_mask:0xf bank_mask:0xf
  v_mov_b32 v245, v244
  s_nop 1
  v_permlane16_swap_b32 v244, v245
  v_add_f32 v244, v244, v245
  v_mov_b32 v245, v244
  s_nop 1
  v_permlane32_swap_b32 v244, v245
  v_add_f32 v244, v244, v245
  s_and_b32 s59, s62, 1
  s_lshl_b32 s59, s59, 4
  s_add_u32 s59, s59, 140432
  s_lshl_b32 s60, s52, 2
  s_add_u32 s60, s60, s59
  v_mov_b32 v245, s60
  ds_write_b32 v245, v244
  s_waitcnt lgkmcnt(0)
  s_barrier
  v_mov_b32 v245, s59
  ds_read_b128 v[248:251], v245
  s_waitcnt lgkmcnt(0)
  v_add_f32 v248, v248, v249
  v_add_f32 v250, v250, v251
  v_add_f32 v248, v248, v250
  v_cvt_pk_bf16_f32 v248, 0, v248
  v_add_f32 v248, v248, v77
  v_cvt_pk_bf16_f32 v248, 0, v248
  v_add_f32 v248, v248, v241
  v_cvt_pk_bf16_f32 v248, v248, v248
  v_cmp_eq_u32 vcc, 0, v0
  v_mov_b32 v249, 2147483648
  s_nop 0
  v_cndmask_b32 v249, v249, v242, vcc
  buffer_store_short v248, v249, s[32:35], 0 offen
  s_add_u32 s62, s62, 1
  s_cmp_lt_u32 s62, s61
  s_cbranch_scc1 L_fb_lp_22
L_exit:
L_end:
  s_endpgm
.section .rodata,"a"
.p2align 6
.amdhsa_kernel sequential_preLN__gqa_block_cached__mixer_token_mlp__decode_kernel
  .amdhsa_next_free_vgpr 512
  .amdhsa_next_free_sgpr 102
  .amdhsa_accum_offset 256
  .amdhsa_group_segment_fixed_size 0
  .amdhsa_kernarg_size 104
  .amdhsa_user_sgpr_count 2
  .amdhsa_user_sgpr_kernarg_segment_ptr 1
  .amdhsa_system_sgpr_workgroup_id_x 1
.end_amdhsa_kernel
```
